```python
import torch

def _softmax(x, axis=-1):
    return torch.softmax(x, dim=axis)
def _gelu(x):
    return torch.nn.functional.gelu(x, approximate="tanh")
def _silu(x):
    return torch.nn.functional.silu(x)
def _sigmoid(x):
    return torch.sigmoid(x)
def _layernorm(x, axis=-1, eps=1e-5):
    m = x.mean(dim=axis, keepdim=True)
    v = x.var(dim=axis, keepdim=True, unbiased=False)
    return (x - m) / torch.sqrt(v + eps)
def _scatter_add(tgt, idx, src, axis=0):
    return tgt.clone().index_add_(axis, idx, src)
def _segment_sum(src, seg, n):
    out = torch.zeros((n,) + src.shape[1:], dtype=src.dtype)
    return out.index_add_(0, seg, src)
def _pad(x, pw):
    flat = tuple(v for pair in reversed(pw) for v in pair)
    return torch.nn.functional.pad(x, flat)

kernel_name = 'concat_heads__linear_attn_block__grouped_kv_mqa__prompt'

def setup_inputs():

    _w = (lambda a: (lambda t: t.to(torch.bfloat16) if t.is_floating_point() else t)(torch.as_tensor(a)))
    def _A_setup():
        B, S, D = 1, 2048, 512
        return {
            "x": _w((lambda *s: torch.randn(*s, dtype=torch.bfloat16) * 0.05)(B, S, D)),
            "wqkv": _w((lambda *s: torch.randn(*s, dtype=torch.bfloat16) * 0.8)(D, 3 * D)),
            "wo": _w((lambda *s: torch.randn(*s, dtype=torch.bfloat16) * 0.05)(D, D)),
        }
    _A_in = _A_setup()

    def _B_setup():
        B, S, D, H = 1, 2048, 512, 32
        Dh = D // H
        return {
            "x": _w((lambda *s: torch.randn(*s, dtype=torch.bfloat16) * 0.05)(B, S, D)),
            "wq": _w((lambda *s: torch.randn(*s, dtype=torch.bfloat16) * 1.6)(D, H * Dh)),
            "wk": _w((lambda *s: torch.randn(*s, dtype=torch.bfloat16) * 1.6)(D, Dh)),
            "wv": _w((lambda *s: torch.randn(*s, dtype=torch.bfloat16) * 0.05)(D, Dh)),
            "wo": _w((lambda *s: torch.randn(*s, dtype=torch.bfloat16) * 0.05)(H * Dh, D)),
        }
    _B_in = _B_setup()

    return {
        "A_x": _A_in["x"],
        "A_wqkv": _A_in["wqkv"],
        "A_wo": _A_in["wo"],
        "B_x": _B_in["x"],
        "B_wq": _B_in["wq"],
        "B_wk": _B_in["wk"],
        "B_wv": _B_in["wv"],
        "B_wo": _B_in["wo"],
    }

def reference(A_x, A_wqkv, A_wo, B_x, B_wq, B_wk, B_wv, B_wo):
    def _A_ref(x, wqkv, wo):
        B, S, D = x.shape
        H = 32; Dh = D // H
        qkv = (lambda x, *d: x.permute(*d))((x @ wqkv).reshape(B, S, 3, H, Dh), 2, 0, 3, 1, 4)
        q, k, v = qkv[0], qkv[1], qkv[2]
        phi = lambda t: torch.where(t > 0, t + 1, torch.exp(t)) + 1e-6
        pq, pk = phi(q), phi(k)
        kv = torch.einsum("bhsd,bhse->bhde", pk, v)
        z = torch.einsum("bhsd->bhd", pk)
        num = torch.einsum("bhqd,bhde->bhqe", pq, kv)
        den = torch.einsum("bhqd,bhd->bhq", pq, z)[..., None] + 1e-6
        o = num / den
        return (lambda x, *d: x.permute(*d))(o, 0, 2, 1, 3).reshape(B, S, D) @ wo

    def _B_ref(x, wq, wk, wv, wo):
        B, S, D = x.shape
        H = 32
        Dh = D // H
        q = (lambda x, *d: x.permute(*d))((x @ wq).reshape(B, S, H, Dh), 0, 2, 1, 3)
        k = x @ wk
        v = x @ wv
        scores = torch.einsum("bhqd,bkd->bhqk", q, k) * (Dh ** -0.5)
        p = _softmax(scores, axis=-1)
        o = torch.einsum("bhqk,bkd->bhqd", p, v)
        return (lambda x, *d: x.permute(*d))(o, 0, 2, 1, 3).reshape(B, S, H * Dh) @ wo

    a = _A_ref(A_x, A_wqkv, A_wo)
    b = _B_ref(B_x, B_wq, B_wk, B_wv, B_wo)
    return torch.concatenate([a, b], axis=-1)
```

```asm
; @launch grid=(256,1,1) block=(1024,1,1) lds=163840
.amdgcn_target "amdgcn-amd-amdhsa--gfx950"
.text
.globl concat_heads__linear_attn_block__grouped_kv_mqa__prompt_kernel
.p2align 8
.type concat_heads__linear_attn_block__grouped_kv_mqa__prompt_kernel,@function
concat_heads__linear_attn_block__grouped_kv_mqa__prompt_kernel:
    s_cmp_ge_u32 s2, 256
    s_cbranch_scc1 L_end
    s_load_dwordx16 s[64:79], s[0:1], 0
    s_load_dwordx2 s[80:81], s[0:1], 64
    s_load_dwordx2 s[82:83], s[0:1], 80
    v_lshrrev_b32 v1, 6, v0
    v_and_b32 v0, 63, v0
    v_readfirstlane_b32 s40, v1
    s_lshr_b32 s52, s2, 5
    s_or_b32 s52, s52, s40
    s_cbranch_scc1 L_nopf
    s_getpc_b64 s[56:57]
L_pc:
    v_lshlrev_b32 v5, 7, v0
    v_add_u32 v4, 0x2000, v5
    global_load_dword v126, v5, s[56:57]
    v_cmp_gt_u32 vcc, L_end-L_pc, v4
    s_and_saveexec_b64 s[88:89], vcc
    global_load_dword v126, v4, s[56:57]
    s_mov_b64 exec, -1
L_nopf:
    s_bfe_u32 s50, s2, 0x30003
    s_and_b32 s52, s2, 3
    s_lshl2_add_u32 s41, s50, s52
    s_lshr_b32 s51, s2, 6
    s_bfe_u32 s52, s2, 0x10002
    s_lshl1_add_u32 s42, s51, s52
    v_lshlrev_b32 v119, 4, v0
    v_mov_b32 v117, 0
    s_lshl_b32 s58, s41, 16
    s_mov_b32 s18, 0x200000
    s_mov_b32 s19, 0x20000
    s_bitcmp1_b32 s40, 2
    s_cbranch_scc0 L_even
    v_and_b32 v2, 15, v0
    v_lshrrev_b32 v3, 4, v0
    v_lshlrev_b32 v4, 10, v2
    v_lshl_add_u32 v4, v3, 4, v4
    s_and_b32 s52, s40, 3
    s_lshr_b32 s53, s40, 3
    s_lshl2_add_u32 s48, s53, s52
    s_lshl_b32 s54, s51, 14
    s_add_u32 s52, s58, s54
    s_lshl_b32 s54, s48, 7
    s_add_u32 s52, s52, s54
    s_lshl_b32 s55, s48, 11
    s_add_u32 m0, s55, 32768
    s_bitcmp1_b32 s42, 0
    s_mov_b32 s26, 0x4000
    s_mov_b32 s27, 0x20000
    s_waitcnt lgkmcnt(0)
    s_cselect_b64 s[24:25], s[76:77], s[74:75]
    s_mov_b64 s[16:17], s[70:71]
    buffer_load_dwordx4 v[80:83], v4, s[16:19], s52 offen
    buffer_load_dwordx4 v[84:87], v4, s[16:19], s52 offen offset:64
    buffer_load_dwordx4 v119, s[24:27], s55 offen lds
    buffer_load_dwordx4 v119, s[24:27], s55 offen offset:1024 lds
    s_load_dword s45, s[82:83], 0
    s_barrier
    s_branch L_kv2
L_Qwaves:
    v_lshrrev_b32 v9, 2, v119
    v_add_u32 v9, 163584, v9
    v_cmp_le_u32 vcc, 56, v0
    v_cmp_le_u32 s[88:89], 60, v0
    v_bfe_u32 v5, v0, 3, 2
    v_cndmask_b32 v8, 0, 4, vcc
    v_cndmask_b32 v8, v8, 64, s[88:89]
    ds_write_b32 v9, v8
    s_waitcnt lgkmcnt(0)
    s_barrier
    s_branch L_Qw2
L_issueB:
    s_mov_b32 s86, 1
    s_branch L_iB
L_issueBA:
    s_mov_b32 s86, 0
L_iB:
    s_and_b32 s63, s63, 7
    s_lshl_b32 s87, s63, 7
    s_add_u32 s87, s87, s58
    s_lshl_b32 s89, s63, 16
    s_add_u32 s89, s89, s59
    s_add_u32 m0, s62, 32768
    s_nop 0
    buffer_load_dwordx4 v24, s[16:19], s87 offen lds
    s_add_u32 m0, s62, 40960
    s_add_u32 s87, s87, 32768
    buffer_load_dwordx4 v25, s[20:23], s89 offen lds
    s_add_u32 s89, s89, 32768
    s_add_u32 m0, s62, 36864
    s_nop 0
    buffer_load_dwordx4 v24, s[16:19], s87 offen lds
    s_add_u32 m0, s62, 45056
    s_add_u32 s87, s87, 32768
    buffer_load_dwordx4 v25, s[20:23], s89 offen lds
    s_add_u32 s63, s63, 1
    s_cmp_eq_u32 s86, 1
    s_cbranch_scc1 L_iX
L_issueA:
    s_and_b32 s60, s60, 7
    s_lshl_b32 s87, s60, 7
    s_add_u32 s87, s87, s58
    s_mul_i32 s88, s60, 196608
    s_add_u32 s88, s88, s59
    s_add_u32 m0, s62, 0
    s_nop 0
    buffer_load_dwordx4 v24, s[4:7], s87 offen lds
    s_add_u32 m0, s62, 8192
    s_add_u32 s87, s87, 32768
    buffer_load_dwordx4 v26, s[8:11], s88 offen offset:0 lds
    s_add_u32 m0, s62, 15360
    s_nop 0
    buffer_load_dwordx4 v26, s[8:11], s88 offen offset:1024 lds
    s_add_u32 m0, s62, 22528
    s_nop 0
    buffer_load_dwordx4 v26, s[8:11], s88 offen offset:2048 lds
    s_add_u32 s88, s88, 98304
    s_add_u32 m0, s62, 4096
    s_nop 0
    buffer_load_dwordx4 v24, s[4:7], s87 offen lds
    s_add_u32 m0, s62, 12288
    s_add_u32 s87, s87, 32768
    buffer_load_dwordx4 v26, s[8:11], s88 offen offset:0 lds
    s_add_u32 m0, s62, 19456
    s_nop 0
    buffer_load_dwordx4 v26, s[8:11], s88 offen offset:1024 lds
    s_add_u32 m0, s62, 26624
    s_nop 0
    buffer_load_dwordx4 v26, s[8:11], s88 offen offset:2048 lds
    s_add_u32 s60, s60, 1
L_iX:
    s_setpc_b64 s[52:53]
L_even:
    s_cmp_lt_u32 s40, 4
    s_cbranch_scc1 L_Qwaves
    v_lshrrev_b32 v6, 3, v0
    v_and_b32 v7, 7, v0
    s_and_b32 s52, s40, 3
    s_lshl_b32 s53, s52, 3
    v_add_u32 v6, s53, v6
    v_bfe_u32 v8, v6, 1, 3
    v_xor_b32 v8, v7, v8
    v_lshlrev_b32 v9, 10, v6
    v_lshl_add_u32 v24, v8, 4, v9
    v_bfe_u32 v8, v6, 1, 1
    v_lshlrev_b32 v8, 2, v8
    v_xor_b32 v8, v7, v8
    v_lshlrev_b32 v8, 4, v8
    v_add_u32 v25, v9, v8
    v_mul_u32_u24 v26, 3072, v6
    v_add_u32 v26, v26, v8
    s_lshl1_add_u32 s60, s51, s50
    s_mov_b32 s63, s60
    s_lshl_b32 s59, s42, 7
    s_lshl_b32 s55, s52, 10
    s_mov_b32 s22, 0x80000
    s_mov_b32 s23, 0x20000
    s_mov_b32 s6, 0x200000
    s_mov_b32 s7, 0x20000
    s_mov_b32 s10, 0x180000
    s_mov_b32 s11, 0x20000
    s_waitcnt lgkmcnt(0)
    s_mov_b64 s[16:17], s[70:71]
    s_mov_b64 s[20:21], s[72:73]
    s_mov_b64 s[4:5], s[64:65]
    s_mov_b64 s[8:9], s[66:67]
    s_barrier
    s_add_u32 s62, s55, 0
    s_call_b64 s[52:53], L_issueA
    s_add_u32 s62, s55, 49152
    s_call_b64 s[52:53], L_issueBA
    s_setprio 3
    s_waitcnt vmcnt(12)
    s_barrier
    s_add_u32 s62, s55, 98304
    s_call_b64 s[52:53], L_issueBA
    s_waitcnt vmcnt(12)
    s_barrier
    s_add_u32 s62, s55, 0
    s_call_b64 s[52:53], L_issueBA
    s_waitcnt vmcnt(12)
    s_barrier
    s_add_u32 s62, s55, 49152
    s_call_b64 s[52:53], L_issueBA
    s_waitcnt vmcnt(12)
    s_barrier
    s_add_u32 s62, s55, 98304
    s_call_b64 s[52:53], L_issueBA
    s_waitcnt vmcnt(12)
    s_barrier
    s_add_u32 s62, s55, 0
    s_call_b64 s[52:53], L_issueBA
    s_waitcnt vmcnt(12)
    s_barrier
    s_add_u32 s62, s55, 49152
    s_call_b64 s[52:53], L_issueBA
    s_and_b32 s46, s40, 3
    s_lshr_b32 s47, s40, 2
    s_lshr_b32 s43, s46, 1
    s_and_b32 s44, s46, 1
    s_lshl_b32 s49, s42, 5
    s_add_u32 s49, s49, s41
    v_mov_b32 v118, 163584
    v_mov_b32 v121, 1
    s_lshl_b32 s90, s46, 11
    v_add_u32 v125, s90, v119
    s_mov_b64 s[36:37], s[82:83]
    s_mov_b32 s38, 0x1000000
    s_mov_b32 s39, 0x20000
    s_waitcnt vmcnt(12)
    s_barrier
    s_add_u32 s62, s55, 98304
    s_call_b64 s[52:53], L_issueB
    s_mov_b64 exec, 1
    ds_add_u32 v118, v121 offset:80
    s_mov_b64 exec, -1
    s_call_b64 s[52:53], L_setup
    s_waitcnt vmcnt(0)
    s_barrier
    s_mov_b32 s86, 8
    s_mov_b32 s62, 163684
    s_movk_i32 s60, 0x2014
    s_mov_b32 s63, 0xff1c1810
    v_mov_b32 v27, 163696
    s_mov_b32 s59, 98304
    s_mov_b32 s90, 8
    s_mov_b32 s58, 16
    s_mov_b32 s84, 2
    s_mov_b32 s85, 3
    s_mov_b32 s87, 106496
    v_add_u32 v26, s87, v119
    v_mad_u32_u24 v12, v14, s87, v13
    s_min_u32 s87, s85, 32
    s_lshl_b32 s87, s87, 12
    s_add_u32 s87, s87, s59
    v_add_u32 v1, s87, v119
    v_mad_u32_u24 v2, v14, s87, v13
    s_mov_b32 s94, 163680
    s_mov_b32 s95, 4
    s_call_b64 s[56:57], L_waitf
    ds_read_b128 v[92:95], v26
    ds_read_b128 v[100:103], v12 offset:0
    ds_read_b128 v[104:107], v12 offset:512
    ds_read_b128 v[96:99], v26 offset:1024
    s_mov_b32 s94, 163640
    s_mov_b32 s95, 4
    s_call_b64 s[56:57], L_waitf
    ds_read_b128 v[4:7], v20
    ds_read_b128 v[8:11], v20 offset:1024
    s_branch L_go
L_kv2:
    v_lshlrev_b32 v10, 8, v3
    v_lshl_add_u32 v10, v2, 3, v10
    v_add_u32 v10, s55, v10
    v_add_u32 v11, s55, v119
    v_mov_b32 v5, 0
    s_and_b32 s46, s40, 3
    s_lshr_b32 s47, s40, 2
    s_lshr_b32 s43, s46, 1
    s_and_b32 s44, s46, 1
    s_lshl_b32 s49, s42, 5
    s_add_u32 s49, s49, s41
    v_mov_b32 v118, 163584
    v_mov_b32 v121, 1
    s_lshl_b32 s90, s46, 11
    v_add_u32 v125, s90, v119
    s_mov_b64 s[36:37], s[82:83]
    s_mov_b32 s38, 0x1000000
    s_mov_b32 s39, 0x20000
    s_setprio 3
    s_cmp_lg_u32 s40, 4
    s_cbranch_scc1 L_nored
    s_lshl_b32 s87, s41, 12
    s_add_u32 s87, s87, 65536
    s_lshr_b32 s88, s51, 1
    s_lshl_b32 s88, s88, 10
    s_and_b32 s89, s51, 1
    s_lshl_b32 s89, s89, 8
    s_add_u32 s88, s88, s89
    s_add_u32 s88, s88, s87
    s_lshl_b32 s89, s51, 9
    s_add_u32 s89, s89, s87
    s_add_u32 s89, s89, 2048
    v_and_b32 v8, 1, v3
    v_lshrrev_b32 v9, 1, v3
    v_lshlrev_b32 v5, 9, v8
    v_lshl_add_u32 v5, v9, 3, v5
    v_lshlrev_b32 v6, 8, v9
    v_lshl_add_u32 v6, v8, 3, v6
    s_lshl_b32 s86, s2, 4
    s_add_u32 s86, s86, 4096
    s_bitcmp1_b32 s42, 0
    s_cselect_b32 s88, s89, s88
    s_cselect_b64 vcc, -1, 0
    v_cndmask_b32 v5, v5, v6, vcc
    v_lshl_add_u32 v5, v2, 4, v5
L_nored:
    s_bitcmp1_b32 s42, 0
    s_waitcnt vmcnt(0)
    ds_read_b64_tr_b16 v[88:89], v10 offset:32768
    ds_read_b64_tr_b16 v[90:91], v10 offset:32896
    ds_read_b64_tr_b16 v[92:93], v10 offset:33792
    ds_read_b64_tr_b16 v[94:95], v10 offset:33920
    s_waitcnt lgkmcnt(0)
    s_cbranch_scc1 L_kvV
    v_mfma_f32_16x16x32_bf16 v[96:99], v[88:91], v[80:83], 0
    v_mfma_f32_16x16x32_bf16 v[96:99], v[92:95], v[84:87], v[96:99]
    s_branch L_kvJ
L_kvV:
    v_mfma_f32_16x16x32_bf16 v[96:99], v[80:83], v[88:91], 0
    v_mfma_f32_16x16x32_bf16 v[96:99], v[84:87], v[92:95], v[96:99]
L_kvJ:
    s_mul_i32 s45, s45, 0x9E3779B1
    s_add_u32 s45, s45, 0x7F4A7C15
    s_nop 5
    ds_write_b128 v11, v[96:99] offset:32768
    s_mov_b64 exec, 1
    ds_add_u32 v118, v121 offset:32
    s_mov_b64 exec, -1
    s_cmp_eq_u32 s47, 3
    s_cbranch_scc1 L_kq3
    s_cmp_lg_u32 s40, 4
    s_cbranch_scc1 L_kq1b
    s_mov_b32 s94, 163616
    s_mov_b32 s95, 8
    s_call_b64 s[56:57], L_waitf
    ds_read_b128 v[60:63], v119 offset:32768
    ds_read_b128 v[64:67], v119 offset:34816
    ds_read_b128 v[68:71], v119 offset:36864
    ds_read_b128 v[72:75], v119 offset:38912
    ds_read_b128 v[76:79], v119 offset:40960
    ds_read_b128 v[80:83], v119 offset:43008
    ds_read_b128 v[84:87], v119 offset:45056
    ds_read_b128 v[88:91], v119 offset:47104
    s_waitcnt lgkmcnt(0)
    v_pk_add_f32 v[60:61], v[60:61], v[64:65]
    v_pk_add_f32 v[62:63], v[62:63], v[66:67]
    v_pk_add_f32 v[68:69], v[68:69], v[72:73]
    v_pk_add_f32 v[70:71], v[70:71], v[74:75]
    v_pk_add_f32 v[76:77], v[76:77], v[80:81]
    v_pk_add_f32 v[78:79], v[78:79], v[82:83]
    v_pk_add_f32 v[84:85], v[84:85], v[88:89]
    v_pk_add_f32 v[86:87], v[86:87], v[90:91]
    v_pk_add_f32 v[60:61], v[60:61], v[68:69]
    v_pk_add_f32 v[62:63], v[62:63], v[70:71]
    v_pk_add_f32 v[76:77], v[76:77], v[84:85]
    v_pk_add_f32 v[78:79], v[78:79], v[86:87]
    v_pk_add_f32 v[60:61], v[60:61], v[76:77]
    v_pk_add_f32 v[62:63], v[62:63], v[78:79]
    v_cvt_pk_bf16_f32 v64, v60, v61
    v_cvt_pk_bf16_f32 v65, v62, v63
    buffer_store_dwordx2 v[64:65], v5, s[36:39], s88 offen sc1
    s_barrier
    s_barrier
    s_waitcnt vmcnt(0)
    v_mov_b32 v122, s45
    s_mov_b64 exec, 1
    buffer_store_dword v122, v119, s[36:39], s86 offen sc1
    s_mov_b64 exec, -1
    s_branch L_kq1c
L_kq1b:
    s_barrier
    s_barrier
L_kq1c:
    s_barrier
    s_call_b64 s[52:53], L_setup
    s_lshl_b32 s60, s46, 10
    s_add_u32 s60, s60, 4096
    s_lshr_b32 s54, s2, 3
    s_lshl_b32 s54, s54, 12
    s_barrier
    s_barrier
    buffer_load_dword v120, v119, s[36:39], s60 offen sc1
    s_barrier
    s_waitcnt vmcnt(0)
    v_cmp_ne_u32 vcc, s45, v120
    s_nop 1
    s_cmp_eq_u64 vcc, 0
    s_cbranch_scc1 L_f1ok
    s_mov_b32 s96, 0
L_pf1:
    buffer_load_dword v120, v119, s[36:39], s60 offen sc1
    s_add_u32 s96, s96, 1
    s_waitcnt vmcnt(0)
    v_cmp_ne_u32 vcc, s45, v120
    s_cmp_gt_u32 s96, 400000
    s_cbranch_scc1 L_pfx2
    s_cmp_eq_u64 vcc, 0
    s_cbranch_scc1 L_pfx2
    s_sleep 2
    s_branch L_pf1
L_pfx2:
L_f1ok:
    s_barrier
    s_mov_b32 s94, 163664
    s_mov_b32 s95, 4
    s_call_b64 s[56:57], L_waitf
    s_lshl_b32 s62, s46, 12
    s_add_u32 s62, s62, 98304
    s_mov_b32 m0, s62
    s_add_u32 s88, s62, s54
    s_and_b32 s88, s88, 0x1ffff
    s_add_u32 s88, s88, 65536
    buffer_load_dwordx4 v119, s[36:39], s88 offen offset:0 sc1 lds
    buffer_load_dwordx4 v119, s[36:39], s88 offen offset:1024 sc1 lds
    buffer_load_dwordx4 v119, s[36:39], s88 offen offset:2048 sc1 lds
    buffer_load_dwordx4 v119, s[36:39], s88 offen offset:3072 sc1 lds
    s_lshl_b32 s62, s46, 12
    s_add_u32 s62, s62, 114688
    s_mov_b32 m0, s62
    s_add_u32 s88, s62, s54
    s_and_b32 s88, s88, 0x1ffff
    s_add_u32 s88, s88, 65536
    buffer_load_dwordx4 v119, s[36:39], s88 offen offset:0 sc1 lds
    buffer_load_dwordx4 v119, s[36:39], s88 offen offset:1024 sc1 lds
    buffer_load_dwordx4 v119, s[36:39], s88 offen offset:2048 sc1 lds
    buffer_load_dwordx4 v119, s[36:39], s88 offen offset:3072 sc1 lds
    s_barrier
    s_waitcnt vmcnt(0)
    s_mov_b64 exec, 1
    ds_add_u32 v118, v121 offset:96
    s_mov_b64 exec, -1
    s_mov_b32 s94, 163640
    s_mov_b32 s95, 4
    s_call_b64 s[56:57], L_waits
    s_mov_b32 s94, 163660
    s_mov_b32 s95, 8
    s_call_b64 s[56:57], L_waits
    s_lshl_b32 s62, s46, 12
    s_add_u32 s62, s62, 0
    s_mov_b32 s89, 3
    s_call_b64 s[52:53], L_issueK
    s_waitcnt vmcnt(0)
    s_mov_b64 exec, 1
    ds_add_u32 v118, v121 offset:100
    s_mov_b64 exec, -1
    s_cmp_lg_u32 s40, 5
    s_cbranch_scc1 L_nogen
    s_cmp_lg_u32 s2, 0
    s_cbranch_scc1 L_nogen
    s_mov_b32 s87, 0
    v_mov_b32 v122, s45
    s_mov_b64 exec, 1
    buffer_store_dword v122, v119, s[36:39], s87 offen sc1
    s_mov_b64 exec, -1
L_nogen:
    s_branch L_grab2
L_kq3:
    v_mov_b32 v4, 0x358637bd
    v_mov_b32 v5, 0x358637bd
    v_mov_b32 v6, 0
    v_mov_b32 v7, 0
    v_pk_mov_b32 v[12:13], v[4:5], v[4:5] op_sel:[0,1]
    v_pk_mov_b32 v[14:15], v[4:5], v[4:5] op_sel:[0,1]
    v_pk_mov_b32 v[16:17], v[4:5], v[4:5] op_sel:[0,1]
    v_pk_mov_b32 v[18:19], v[4:5], v[4:5] op_sel:[0,1]
    v_pk_mov_b32 v[20:21], v[4:5], v[4:5] op_sel:[0,1]
    v_pk_mov_b32 v[22:23], v[4:5], v[4:5] op_sel:[0,1]
    v_pk_mov_b32 v[24:25], v[4:5], v[4:5] op_sel:[0,1]
    v_pk_mov_b32 v[26:27], v[4:5], v[4:5] op_sel:[0,1]
    v_pk_mov_b32 v[28:29], v[4:5], v[4:5] op_sel:[0,1]
    v_pk_mov_b32 v[30:31], v[4:5], v[4:5] op_sel:[0,1]
    v_pk_mov_b32 v[32:33], v[4:5], v[4:5] op_sel:[0,1]
    v_pk_mov_b32 v[34:35], v[4:5], v[4:5] op_sel:[0,1]
    v_pk_mov_b32 v[36:37], v[4:5], v[4:5] op_sel:[0,1]
    v_pk_mov_b32 v[38:39], v[4:5], v[4:5] op_sel:[0,1]
    v_pk_mov_b32 v[40:41], v[4:5], v[4:5] op_sel:[0,1]
    v_pk_mov_b32 v[42:43], v[4:5], v[4:5] op_sel:[0,1]
    v_mfma_f32_32x32x8_bf16 v[44:59], v[6:7], v[6:7], 0
    v_and_b32 v6, 31, v0
    v_lshrrev_b32 v7, 5, v0
    v_bfe_u32 v8, v6, 1, 3
    v_xor_b32 v8, v8, v7
    s_lshl_b32 s87, s43, 12
    v_lshlrev_b32 v9, 7, v6
    v_lshl_add_u32 v9, v8, 4, v9
    v_add_u32 v124, s87, v9
    v_bfe_u32 v8, v0, 2, 2
    v_lshl_add_u32 v8, v7, 3, v8
    v_lshlrev_b32 v8, 7, v8
    v_bfe_u32 v9, v0, 3, 1
    v_xor_b32 v9, s44, v9
    v_lshl_add_u32 v8, v9, 6, v8
    v_bfe_u32 v9, v0, 4, 1
    v_lshl_add_u32 v8, v9, 5, v8
    v_and_b32 v9, 3, v0
    v_lshl_add_u32 v116, v9, 3, v8
    v_lshrrev_b32 v6, 3, v0
    v_and_b32 v7, 7, v0
    v_bfe_u32 v8, v6, 1, 1
    v_lshlrev_b32 v8, 2, v8
    v_xor_b32 v8, v7, v8
    v_lshlrev_b32 v9, 10, v6
    v_lshl_add_u32 v117, v8, 4, v9
    v_add_u32 v4, 0, v124
    v_xor_b32 v5, 32, v4
    v_xor_b32 v6, 64, v4
    v_xor_b32 v7, 96, v4
    v_add_u32 v8, 8192, v116
    s_mov_b32 s86, 7
    s_mov_b32 s84, 0
    s_setprio 3
    s_barrier
    ds_read_b128 v[60:63], v4
    ds_read_b64_tr_b16 v[64:65], v8 offset:0
    ds_read_b64_tr_b16 v[66:67], v8 offset:512
    ds_read_b64_tr_b16 v[68:69], v8 offset:8192
    ds_read_b64_tr_b16 v[70:71], v8 offset:8704
    ds_read_b64_tr_b16 v[72:73], v8 offset:16384
    ds_read_b64_tr_b16 v[74:75], v8 offset:16896
L_Aloop:
    ds_read_b128 v[76:79], v5
    ds_read_b64_tr_b16 v[80:81], v8 offset:2048
    ds_read_b64_tr_b16 v[82:83], v8 offset:2560
    ds_read_b64_tr_b16 v[84:85], v8 offset:10240
    ds_read_b64_tr_b16 v[86:87], v8 offset:10752
    ds_read_b64_tr_b16 v[88:89], v8 offset:18432
    ds_read_b64_tr_b16 v[90:91], v8 offset:18944
    s_waitcnt lgkmcnt(7)
    v_mfma_f32_32x32x16_bf16 v[12:27], v[64:67], v[60:63], v[12:27]
    v_mfma_f32_32x32x16_bf16 v[28:43], v[60:63], v[68:71], v[28:43]
    v_mfma_f32_32x32x16_bf16 v[44:59], v[60:63], v[72:75], v[44:59]
    ds_read_b128 v[60:63], v6
    ds_read_b64_tr_b16 v[64:65], v8 offset:4096
    ds_read_b64_tr_b16 v[66:67], v8 offset:4608
    ds_read_b64_tr_b16 v[68:69], v8 offset:12288
    ds_read_b64_tr_b16 v[70:71], v8 offset:12800
    ds_read_b64_tr_b16 v[72:73], v8 offset:20480
    ds_read_b64_tr_b16 v[74:75], v8 offset:20992
    s_waitcnt lgkmcnt(7)
    v_mfma_f32_32x32x16_bf16 v[12:27], v[80:83], v[76:79], v[12:27]
    v_mfma_f32_32x32x16_bf16 v[28:43], v[76:79], v[84:87], v[28:43]
    v_mfma_f32_32x32x16_bf16 v[44:59], v[76:79], v[88:91], v[44:59]
    ds_read_b128 v[76:79], v7
    ds_read_b64_tr_b16 v[80:81], v8 offset:6144
    ds_read_b64_tr_b16 v[82:83], v8 offset:6656
    ds_read_b64_tr_b16 v[84:85], v8 offset:14336
    ds_read_b64_tr_b16 v[86:87], v8 offset:14848
    ds_read_b64_tr_b16 v[88:89], v8 offset:22528
    ds_read_b64_tr_b16 v[90:91], v8 offset:23040
    s_waitcnt lgkmcnt(7)
    v_mfma_f32_32x32x16_bf16 v[12:27], v[64:67], v[60:63], v[12:27]
    v_mfma_f32_32x32x16_bf16 v[28:43], v[60:63], v[68:71], v[28:43]
    v_mfma_f32_32x32x16_bf16 v[44:59], v[60:63], v[72:75], v[44:59]
    s_add_u32 s84, s84, 1
    s_cmp_eq_u32 s84, 3
    s_cselect_b32 s84, 0, s84
    s_mov_b32 s87, 49152
    s_cselect_b32 s87, -98304, s87
    v_add_u32 v4, s87, v4
    v_add_u32 v5, s87, v5
    v_add_u32 v6, s87, v6
    v_add_u32 v7, s87, v7
    v_add_u32 v8, s87, v8
    s_cmp_eq_u32 s86, 0
    s_waitcnt lgkmcnt(0)
    s_cbranch_scc1 L_Aend
    s_barrier
    ds_read_b128 v[60:63], v4
    ds_read_b64_tr_b16 v[64:65], v8 offset:0
    ds_read_b64_tr_b16 v[66:67], v8 offset:512
    ds_read_b64_tr_b16 v[68:69], v8 offset:8192
    ds_read_b64_tr_b16 v[70:71], v8 offset:8704
    ds_read_b64_tr_b16 v[72:73], v8 offset:16384
    ds_read_b64_tr_b16 v[74:75], v8 offset:16896
    v_mfma_f32_32x32x16_bf16 v[12:27], v[80:83], v[76:79], v[12:27]
    v_mfma_f32_32x32x16_bf16 v[28:43], v[76:79], v[84:87], v[28:43]
    v_mfma_f32_32x32x16_bf16 v[44:59], v[76:79], v[88:91], v[44:59]
    s_sub_u32 s86, s86, 1
    s_branch L_Aloop
L_Aend:
    s_mov_b64 exec, 1
    ds_add_u32 v118, v121 offset:76
    s_mov_b64 exec, -1
    v_mfma_f32_32x32x16_bf16 v[12:27], v[80:83], v[76:79], v[12:27]
    v_mfma_f32_32x32x16_bf16 v[28:43], v[76:79], v[84:87], v[28:43]
    v_mfma_f32_32x32x16_bf16 v[44:59], v[76:79], v[88:91], v[44:59]
    s_setprio 3
    s_mov_b32 s88, 0x3fb8aa3b
    s_mov_b32 s89, s88
    s_nop 9
    v_cvt_pk_bf16_f32 v92, v44, v45
    v_cvt_pk_bf16_f32 v93, v46, v47
    v_cvt_pk_bf16_f32 v94, v48, v49
    v_cvt_pk_bf16_f32 v95, v50, v51
    v_cvt_pk_bf16_f32 v96, v52, v53
    v_cvt_pk_bf16_f32 v97, v54, v55
    v_cvt_pk_bf16_f32 v98, v56, v57
    v_cvt_pk_bf16_f32 v99, v58, v59
    v_pk_mul_f32 v[60:61], v[28:29], s[88:89]
    v_pk_mul_f32 v[62:63], v[30:31], s[88:89]
    v_pk_mul_f32 v[64:65], v[32:33], s[88:89]
    v_pk_mul_f32 v[66:67], v[34:35], s[88:89]
    v_pk_mul_f32 v[68:69], v[36:37], s[88:89]
    v_pk_mul_f32 v[70:71], v[38:39], s[88:89]
    v_pk_mul_f32 v[72:73], v[40:41], s[88:89]
    v_pk_mul_f32 v[74:75], v[42:43], s[88:89]
    v_exp_f32_e64 v60, v60 clamp
    v_exp_f32_e64 v61, v61 clamp
    v_exp_f32_e64 v62, v62 clamp
    v_exp_f32_e64 v63, v63 clamp
    v_exp_f32_e64 v64, v64 clamp
    v_exp_f32_e64 v65, v65 clamp
    v_exp_f32_e64 v66, v66 clamp
    v_exp_f32_e64 v67, v67 clamp
    v_exp_f32_e64 v68, v68 clamp
    v_exp_f32_e64 v69, v69 clamp
    v_exp_f32_e64 v70, v70 clamp
    v_exp_f32_e64 v71, v71 clamp
    v_exp_f32_e64 v72, v72 clamp
    v_exp_f32_e64 v73, v73 clamp
    v_exp_f32_e64 v74, v74 clamp
    v_exp_f32_e64 v75, v75 clamp
    v_max_f32 v28, 0x358637bd, v28
    v_max_f32 v29, 0x358637bd, v29
    v_max_f32 v30, 0x358637bd, v30
    v_max_f32 v31, 0x358637bd, v31
    v_max_f32 v32, 0x358637bd, v32
    v_max_f32 v33, 0x358637bd, v33
    v_max_f32 v34, 0x358637bd, v34
    v_max_f32 v35, 0x358637bd, v35
    v_max_f32 v36, 0x358637bd, v36
    v_max_f32 v37, 0x358637bd, v37
    v_max_f32 v38, 0x358637bd, v38
    v_max_f32 v39, 0x358637bd, v39
    v_max_f32 v40, 0x358637bd, v40
    v_max_f32 v41, 0x358637bd, v41
    v_max_f32 v42, 0x358637bd, v42
    v_max_f32 v43, 0x358637bd, v43
    v_pk_add_f32 v[28:29], v[28:29], v[60:61]
    v_pk_add_f32 v[30:31], v[30:31], v[62:63]
    v_pk_add_f32 v[32:33], v[32:33], v[64:65]
    v_pk_add_f32 v[34:35], v[34:35], v[66:67]
    v_pk_add_f32 v[36:37], v[36:37], v[68:69]
    v_pk_add_f32 v[38:39], v[38:39], v[70:71]
    v_pk_add_f32 v[40:41], v[40:41], v[72:73]
    v_pk_add_f32 v[42:43], v[42:43], v[74:75]
    v_cvt_pk_bf16_f32 v100, v28, v29
    v_cvt_pk_bf16_f32 v101, v30, v31
    v_cvt_pk_bf16_f32 v102, v32, v33
    v_cvt_pk_bf16_f32 v103, v34, v35
    v_cvt_pk_bf16_f32 v104, v36, v37
    v_cvt_pk_bf16_f32 v105, v38, v39
    v_cvt_pk_bf16_f32 v106, v40, v41
    v_cvt_pk_bf16_f32 v107, v42, v43
    s_mov_b32 s92, 0xffff0000
    s_mov_b32 s93, 0xffff0000
    v_mov_b32 v4, 0x3f803f80
    v_cndmask_b32 v76, v92, v4, s[92:93]
    v_cndmask_b32 v77, v93, v4, s[92:93]
    v_cndmask_b32 v78, v94, v4, s[92:93]
    v_cndmask_b32 v79, v95, v4, s[92:93]
    v_cndmask_b32 v80, v96, v4, s[92:93]
    v_cndmask_b32 v81, v97, v4, s[92:93]
    v_cndmask_b32 v82, v98, v4, s[92:93]
    v_cndmask_b32 v83, v99, v4, s[92:93]
    v_cndmask_b32 v84, v4, v92, s[92:93]
    v_cndmask_b32 v85, v4, v93, s[92:93]
    v_cndmask_b32 v86, v4, v94, s[92:93]
    v_cndmask_b32 v87, v4, v95, s[92:93]
    v_cndmask_b32 v88, v4, v96, s[92:93]
    v_cndmask_b32 v89, v4, v97, s[92:93]
    v_cndmask_b32 v90, v4, v98, s[92:93]
    v_cndmask_b32 v91, v4, v99, s[92:93]
    s_nop 0
    v_mfma_f32_32x32x16_bf16 v[28:43], v[100:103], v[76:79], 0
    v_mfma_f32_32x32x16_bf16 v[44:59], v[100:103], v[84:87], 0
    v_mfma_f32_32x32x16_bf16 v[28:43], v[104:107], v[80:83], v[28:43]
    v_mfma_f32_32x32x16_bf16 v[44:59], v[104:107], v[88:91], v[44:59]
    s_bfe_u32 s60, s45, 0x80000
    s_max_u32 s60, s60, 1
    s_bfe_u32 s61, s45, 0x80008
    s_max_u32 s61, s61, 1
    s_bfe_u32 s62, s45, 0x80010
    s_max_u32 s62, s62, 1
    s_bfe_u32 s63, s45, 0x80018
    s_max_u32 s63, s63, 1
    s_movk_i32 s59, 0xff00
    v_mov_b32 v10, s59
    s_lshl_b32 s85, s49, 13
    s_add_u32 s85, s85, 6291456
    s_lshl1_add_u32 s86, s41, s43
    s_lshl3_add_u32 s86, s86, s42
    s_lshl1_add_u32 s86, s86, s44
    s_lshl_b32 s86, s86, 11
    v_xor_b32 v4, 4096, v125
    v_add_u32 v4, 131072, v4
    v_add_u32 v5, 131072, v125
    s_mov_b32 s94, 163668
    s_mov_b32 s95, 4
    s_call_b64 s[56:57], L_waitf
    s_cmp_eq_u32 s43, 0
    s_cbranch_scc1 L_px0
    ds_write_b128 v4, v[28:31]
    ds_write_b128 v4, v[32:35] offset:1024
    s_waitcnt lgkmcnt(0)
    s_mov_b64 exec, 1
    ds_add_u32 v118, v121 offset:68
    s_mov_b64 exec, -1
    v_pk_mov_b32 v[28:29], v[52:53], v[52:53] op_sel:[0,1]
    v_pk_mov_b32 v[30:31], v[54:55], v[54:55] op_sel:[0,1]
    v_pk_mov_b32 v[32:33], v[56:57], v[56:57] op_sel:[0,1]
    v_pk_mov_b32 v[34:35], v[58:59], v[58:59] op_sel:[0,1]
    s_branch L_px1
L_px0:
    ds_write_b128 v4, v[52:55]
    ds_write_b128 v4, v[56:59] offset:1024
    s_waitcnt lgkmcnt(0)
    s_mov_b64 exec, 1
    ds_add_u32 v118, v121 offset:68
    s_mov_b64 exec, -1
L_px1:
    s_mov_b32 s94, 163652
    s_mov_b32 s95, 4
    s_call_b64 s[56:57], L_waitf
    ds_read_b128 v[60:63], v5
    ds_read_b128 v[64:67], v5 offset:1024
    s_waitcnt lgkmcnt(0)
    s_mov_b64 exec, 1
    ds_add_u32 v118, v121 offset:72
    s_mov_b64 exec, -1
    v_pk_add_f32 v[28:29], v[28:29], v[60:61]
    v_pk_add_f32 v[30:31], v[30:31], v[62:63]
    v_pk_add_f32 v[32:33], v[32:33], v[64:65]
    v_pk_add_f32 v[34:35], v[34:35], v[66:67]
    v_and_or_b32 v28, v28, v10, s60
    v_and_or_b32 v29, v29, v10, s61
    v_and_or_b32 v30, v30, v10, s62
    v_and_or_b32 v31, v31, v10, s63
    buffer_store_dwordx4 v[28:31], v125, s[36:39], s85 offen offset:0 sc1
    v_and_or_b32 v32, v32, v10, s60
    v_and_or_b32 v33, v33, v10, s61
    v_and_or_b32 v34, v34, v10, s62
    v_and_or_b32 v35, v35, v10, s63
    buffer_store_dwordx4 v[32:35], v125, s[36:39], s85 offen offset:1024 sc1
    s_setprio 3
    v_pk_mul_f32 v[60:61], v[12:13], s[88:89]
    v_pk_mul_f32 v[62:63], v[14:15], s[88:89]
    v_pk_mul_f32 v[64:65], v[16:17], s[88:89]
    v_pk_mul_f32 v[66:67], v[18:19], s[88:89]
    v_pk_mul_f32 v[68:69], v[20:21], s[88:89]
    v_pk_mul_f32 v[70:71], v[22:23], s[88:89]
    v_pk_mul_f32 v[72:73], v[24:25], s[88:89]
    v_pk_mul_f32 v[74:75], v[26:27], s[88:89]
    v_exp_f32_e64 v60, v60 clamp
    v_exp_f32_e64 v61, v61 clamp
    v_exp_f32_e64 v62, v62 clamp
    v_exp_f32_e64 v63, v63 clamp
    v_exp_f32_e64 v64, v64 clamp
    v_exp_f32_e64 v65, v65 clamp
    v_exp_f32_e64 v66, v66 clamp
    v_exp_f32_e64 v67, v67 clamp
    v_exp_f32_e64 v68, v68 clamp
    v_exp_f32_e64 v69, v69 clamp
    v_exp_f32_e64 v70, v70 clamp
    v_exp_f32_e64 v71, v71 clamp
    v_exp_f32_e64 v72, v72 clamp
    v_exp_f32_e64 v73, v73 clamp
    v_exp_f32_e64 v74, v74 clamp
    v_exp_f32_e64 v75, v75 clamp
    v_max_f32 v12, 0x358637bd, v12
    v_max_f32 v13, 0x358637bd, v13
    v_max_f32 v14, 0x358637bd, v14
    v_max_f32 v15, 0x358637bd, v15
    v_max_f32 v16, 0x358637bd, v16
    v_max_f32 v17, 0x358637bd, v17
    v_max_f32 v18, 0x358637bd, v18
    v_max_f32 v19, 0x358637bd, v19
    v_max_f32 v20, 0x358637bd, v20
    v_max_f32 v21, 0x358637bd, v21
    v_max_f32 v22, 0x358637bd, v22
    v_max_f32 v23, 0x358637bd, v23
    v_max_f32 v24, 0x358637bd, v24
    v_max_f32 v25, 0x358637bd, v25
    v_max_f32 v26, 0x358637bd, v26
    v_max_f32 v27, 0x358637bd, v27
    v_pk_add_f32 v[12:13], v[12:13], v[60:61]
    v_pk_add_f32 v[14:15], v[14:15], v[62:63]
    v_pk_add_f32 v[16:17], v[16:17], v[64:65]
    v_pk_add_f32 v[18:19], v[18:19], v[66:67]
    v_pk_add_f32 v[20:21], v[20:21], v[68:69]
    v_pk_add_f32 v[22:23], v[22:23], v[70:71]
    v_pk_add_f32 v[24:25], v[24:25], v[72:73]
    v_pk_add_f32 v[26:27], v[26:27], v[74:75]
    v_cvt_pk_bf16_f32 v108, v12, v13
    v_cvt_pk_bf16_f32 v109, v14, v15
    v_cvt_pk_bf16_f32 v110, v16, v17
    v_cvt_pk_bf16_f32 v111, v18, v19
    v_cvt_pk_bf16_f32 v112, v20, v21
    v_cvt_pk_bf16_f32 v113, v22, v23
    v_cvt_pk_bf16_f32 v114, v24, v25
    v_cvt_pk_bf16_f32 v115, v26, v27
    s_setprio 3
    v_mov_b32 v64, -1
    v_mov_b32 v65, -1
    v_mov_b32 v66, -1
    v_mov_b32 v67, -1
    s_add_u32 s87, s86, 4194304
    buffer_store_dwordx4 v[64:67], v119, s[36:39], s87 offen sc1
    buffer_store_dwordx4 v[64:67], v119, s[36:39], s87 offen offset:1024 sc1
    s_lshr_b32 s54, s2, 3
    s_lshl_b32 s54, s54, 12
    s_mov_b32 s85, s62
    s_lshl_b32 s62, s46, 12
    s_add_u32 s62, s62, 49152
    s_mov_b32 s89, 3
    s_call_b64 s[52:53], L_issueK
    s_mov_b32 s62, s85
    s_waitcnt vmcnt(0)
    s_mov_b64 exec, 1
    ds_add_u32 v118, v121 offset:104
    s_mov_b64 exec, -1
    s_mov_b32 s14, 0x80000
    s_mov_b32 s15, 0x20000
    s_lshl_b32 s88, s46, 17
    s_lshl_b32 s87, s42, 7
    s_add_u32 s88, s88, s87
    s_add_u32 s89, s88, 0x10000
    v_lshlrev_b32 v68, 10, v0
    s_mov_b64 s[12:13], s[68:69]
    buffer_load_dword v126, v68, s[12:15], s88 offen
    buffer_load_dword v126, v68, s[12:15], s89 offen
    s_mov_b64 s[12:13], s[78:79]
    buffer_load_dword v126, v68, s[12:15], s88 offen
    buffer_load_dword v126, v68, s[12:15], s89 offen
    s_cmp_lg_u32 s40, 12
    s_cbranch_scc1 L_T5w
    s_lshr_b32 s89, s41, 3
    v_lshrrev_b32 v4, 4, v0
    v_lshlrev_b32 v4, 13, v4
    v_bfe_u32 v5, v0, 3, 1
    v_lshlrev_b32 v5, 10, v5
    v_and_b32 v6, 7, v0
    v_lshl_add_u32 v5, v6, 4, v5
    v_add_u32 v4, v4, v5
    s_lshl_b32 s84, s42, 18
    s_lshl_b32 s89, s89, 11
    s_add_u32 s84, s84, s89
    s_and_b32 s88, s41, 7
    s_lshl_b32 s88, s88, 7
    s_add_u32 s84, s84, s88
    s_add_u32 s84, s84, 6291456
    s_lshr_b32 s89, s49, 3
    s_lshl_b32 s89, s89, 11
    s_add_u32 s89, s89, s88
    s_add_u32 s89, s89, 262144
    s_mov_b32 s96, 0
    s_waitcnt vmcnt(0)
L_R1:
    s_mov_b32 s87, s84
    buffer_load_dwordx4 v[12:15], v4, s[36:39], s87 offen sc1
    s_add_u32 s87, s87, 32768
    buffer_load_dwordx4 v[16:19], v4, s[36:39], s87 offen sc1
    s_add_u32 s87, s87, 32768
    buffer_load_dwordx4 v[20:23], v4, s[36:39], s87 offen sc1
    s_add_u32 s87, s87, 32768
    buffer_load_dwordx4 v[24:27], v4, s[36:39], s87 offen sc1
    s_add_u32 s87, s87, 32768
    buffer_load_dwordx4 v[28:31], v4, s[36:39], s87 offen sc1
    s_add_u32 s87, s87, 32768
    buffer_load_dwordx4 v[32:35], v4, s[36:39], s87 offen sc1
    s_add_u32 s87, s87, 32768
    buffer_load_dwordx4 v[36:39], v4, s[36:39], s87 offen sc1
    s_add_u32 s87, s87, 32768
    buffer_load_dwordx4 v[40:43], v4, s[36:39], s87 offen sc1
    s_waitcnt vmcnt(0)
    v_msad_u8 v6, v12, s60, 0
    v_msad_u8 v7, v13, s61, 0
    v_msad_u8 v6, v14, s62, v6
    v_msad_u8 v7, v15, s63, v7
    v_msad_u8 v6, v16, s60, v6
    v_msad_u8 v7, v17, s61, v7
    v_msad_u8 v6, v18, s62, v6
    v_msad_u8 v7, v19, s63, v7
    v_msad_u8 v6, v20, s60, v6
    v_msad_u8 v7, v21, s61, v7
    v_msad_u8 v6, v22, s62, v6
    v_msad_u8 v7, v23, s63, v7
    v_msad_u8 v6, v24, s60, v6
    v_msad_u8 v7, v25, s61, v7
    v_msad_u8 v6, v26, s62, v6
    v_msad_u8 v7, v27, s63, v7
    v_msad_u8 v6, v28, s60, v6
    v_msad_u8 v7, v29, s61, v7
    v_msad_u8 v6, v30, s62, v6
    v_msad_u8 v7, v31, s63, v7
    v_msad_u8 v6, v32, s60, v6
    v_msad_u8 v7, v33, s61, v7
    v_msad_u8 v6, v34, s62, v6
    v_msad_u8 v7, v35, s63, v7
    v_msad_u8 v6, v36, s60, v6
    v_msad_u8 v7, v37, s61, v7
    v_msad_u8 v6, v38, s62, v6
    v_msad_u8 v7, v39, s63, v7
    v_msad_u8 v6, v40, s60, v6
    v_msad_u8 v7, v41, s61, v7
    v_msad_u8 v6, v42, s62, v6
    v_msad_u8 v7, v43, s63, v7
    v_or_b32 v11, v6, v7
    v_cmp_ne_u32 vcc, 0, v11
    s_add_u32 s96, s96, 1
    s_cmp_gt_u32 s96, 400000
    s_cbranch_scc1 L_ck3
    s_cmp_eq_u64 vcc, 0
    s_cbranch_scc1 L_ck3
    s_sleep 16
    s_branch L_R1
L_ck3:
    v_pk_add_f32 v[12:13], v[12:13], v[16:17]
    v_pk_add_f32 v[14:15], v[14:15], v[18:19]
    v_pk_add_f32 v[20:21], v[20:21], v[24:25]
    v_pk_add_f32 v[22:23], v[22:23], v[26:27]
    v_pk_add_f32 v[28:29], v[28:29], v[32:33]
    v_pk_add_f32 v[30:31], v[30:31], v[34:35]
    v_pk_add_f32 v[36:37], v[36:37], v[40:41]
    v_pk_add_f32 v[38:39], v[38:39], v[42:43]
    v_pk_add_f32 v[12:13], v[12:13], v[20:21]
    v_pk_add_f32 v[14:15], v[14:15], v[22:23]
    v_pk_add_f32 v[28:29], v[28:29], v[36:37]
    v_pk_add_f32 v[30:31], v[30:31], v[38:39]
    v_pk_add_f32 v[12:13], v[12:13], v[28:29]
    v_pk_add_f32 v[14:15], v[14:15], v[30:31]
    v_pk_mov_b32 v[16:17], v[12:13], v[12:13] op_sel:[0,1]
    v_pk_mov_b32 v[18:19], v[14:15], v[14:15] op_sel:[0,1]
    s_nop 1
    v_permlane32_swap_b32 v12, v16
    v_permlane32_swap_b32 v13, v17
    v_permlane32_swap_b32 v14, v18
    v_permlane32_swap_b32 v15, v19
    v_pk_add_f32 v[12:13], v[12:13], v[16:17]
    v_pk_add_f32 v[14:15], v[14:15], v[18:19]
    v_pk_mov_b32 v[16:17], v[12:13], v[12:13] op_sel:[0,1]
    v_pk_mov_b32 v[18:19], v[14:15], v[14:15] op_sel:[0,1]
    s_nop 1
    v_permlane16_swap_b32 v12, v16
    v_permlane16_swap_b32 v13, v17
    v_permlane16_swap_b32 v14, v18
    v_permlane16_swap_b32 v15, v19
    v_pk_add_f32 v[12:13], v[12:13], v[16:17]
    v_pk_add_f32 v[14:15], v[14:15], v[18:19]
    v_and_or_b32 v12, v12, v10, s60
    v_and_or_b32 v13, v13, v10, s61
    v_and_or_b32 v14, v14, v10, s62
    v_and_or_b32 v15, v15, v10, s63
    s_mov_b64 exec, 0xffff
    buffer_store_dwordx4 v[12:15], v5, s[36:39], s89 offen sc1
    s_mov_b64 exec, -1
    s_waitcnt vmcnt(0)
    s_mov_b64 exec, 1
    ds_add_u32 v118, v121 offset:60
    s_mov_b64 exec, -1
L_T5w:
    s_mov_b32 s94, 163644
    s_mov_b32 s95, 1
    s_call_b64 s[56:57], L_waitl
    s_lshl2_add_u32 s87, s42, s44
    s_lshl_b32 s87, s87, 11
    s_add_u32 s87, s87, 262144
    s_add_u32 s89, s87, 4096
    s_add_u32 s88, s86, 2097152
    s_lshl3_add_u32 s86, s41, s42
    s_lshl2_add_u32 s86, s86, s46
    s_lshl_b32 s86, s86, 4
    s_add_u32 s86, s86, 32768
    s_mov_b32 s96, 0
L_T5p:
    buffer_load_dwordx4 v[76:79], v119, s[36:39], s87 offen offset:0 sc1
    buffer_load_dwordx4 v[80:83], v119, s[36:39], s87 offen offset:1024 sc1
    buffer_load_dwordx4 v[84:87], v119, s[36:39], s89 offen offset:0 sc1
    buffer_load_dwordx4 v[88:91], v119, s[36:39], s89 offen offset:1024 sc1
    s_waitcnt vmcnt(0)
    v_msad_u8 v6, v76, s60, 0
    v_msad_u8 v7, v77, s61, 0
    v_msad_u8 v6, v78, s62, v6
    v_msad_u8 v7, v79, s63, v7
    v_msad_u8 v6, v80, s60, v6
    v_msad_u8 v7, v81, s61, v7
    v_msad_u8 v6, v82, s62, v6
    v_msad_u8 v7, v83, s63, v7
    v_msad_u8 v6, v84, s60, v6
    v_msad_u8 v7, v85, s61, v7
    v_msad_u8 v6, v86, s62, v6
    v_msad_u8 v7, v87, s63, v7
    v_msad_u8 v6, v88, s60, v6
    v_msad_u8 v7, v89, s61, v7
    v_msad_u8 v6, v90, s62, v6
    v_msad_u8 v7, v91, s63, v7
    v_or_b32 v11, v6, v7
    v_cmp_ne_u32 vcc, 0, v11
    s_add_u32 s96, s96, 1
    s_cmp_gt_u32 s96, 400000
    s_cbranch_scc1 L_ck4
    s_cmp_eq_u64 vcc, 0
    s_cbranch_scc1 L_ck4
    s_sleep 16
    s_branch L_T5p
L_ck4:
    v_cvt_pk_bf16_f32 v16, v76, v77
    v_cvt_pk_bf16_f32 v17, v78, v79
    v_cvt_pk_bf16_f32 v18, v80, v81
    v_cvt_pk_bf16_f32 v19, v82, v83
    v_cvt_pk_bf16_f32 v20, v84, v85
    v_cvt_pk_bf16_f32 v21, v86, v87
    v_cvt_pk_bf16_f32 v22, v88, v89
    v_cvt_pk_bf16_f32 v23, v90, v91
    s_nop 1
    v_mfma_f32_32x32x16_bf16 v[28:43], v[16:19], v[108:111], 0
    v_mfma_f32_32x32x16_bf16 v[44:59], v[20:23], v[112:115], 0
    s_nop 11
    v_add_f32 v60, 0x358637bd, v36
    v_add_f32 v61, 0x358637bd, v44
    v_pk_mov_b32 v[44:45], v[52:53], v[52:53] op_sel:[0,1]
    v_pk_mov_b32 v[46:47], v[54:55], v[54:55] op_sel:[0,1]
    v_pk_mov_b32 v[48:49], v[56:57], v[56:57] op_sel:[0,1]
    v_pk_mov_b32 v[50:51], v[58:59], v[58:59] op_sel:[0,1]
    s_call_b64 s[52:53], L_normstore
    s_waitcnt vmcnt(0)
    v_mov_b32 v122, s45
    s_mov_b64 exec, 1
    buffer_store_dword v122, v119, s[36:39], s86 offen sc1
    s_mov_b64 exec, -1
    s_setprio 3
    s_branch L_out
L_grab2:
    v_mov_b32 v61, 2
    s_mov_b64 exec, 1
    ds_add_rtn_u32 v16, v15, v61
    s_mov_b64 exec, -1
    s_waitcnt lgkmcnt(0)
    v_readfirstlane_b32 s85, v16
    s_mov_b32 s94, 163640
    s_mov_b32 s95, 4
    s_call_b64 s[56:57], L_waitf
    ds_read_b128 v[4:7], v20
    ds_read_b128 v[8:11], v20 offset:1024
    s_branch L_start
L_Qw2:
    v_and_b32 v7, 7, v0
    v_cmp_gt_u32 vcc, 4, v7
    v_lshlrev_b32 v4, 2, v7
    v_lshl_add_u32 v4, v5, 9, v4
    v_mov_b32 v5, 0x3f803f80
    v_add_u32 v4, 157696, v4
    v_cndmask_b32 v8, 0, v5, vcc
    ds_write_b32 v4, v8
    s_and_b32 s46, s40, 3
    s_lshr_b32 s47, s40, 2
    s_lshr_b32 s43, s46, 1
    s_and_b32 s44, s46, 1
    s_lshl_b32 s49, s42, 5
    s_add_u32 s49, s49, s41
    v_mov_b32 v118, 163584
    v_mov_b32 v121, 1
    s_lshl_b32 s90, s46, 11
    v_add_u32 v125, s90, v119
    s_mov_b64 s[36:37], s[82:83]
    s_mov_b32 s38, 0x1000000
    s_mov_b32 s39, 0x20000
    v_and_b32 v6, 31, v0
    v_lshrrev_b32 v7, 5, v0
    v_bfe_u32 v8, v6, 1, 3
    v_xor_b32 v8, v8, v7
    s_lshl_b32 s87, s43, 12
    v_lshlrev_b32 v9, 7, v6
    v_lshl_add_u32 v9, v8, 4, v9
    v_add_u32 v124, s87, v9
    v_bfe_u32 v8, v0, 2, 2
    v_lshl_add_u32 v8, v7, 3, v8
    v_lshlrev_b32 v8, 7, v8
    v_bfe_u32 v9, v0, 3, 1
    v_xor_b32 v9, s44, v9
    v_lshl_add_u32 v8, v9, 6, v8
    v_bfe_u32 v9, v0, 4, 1
    v_lshl_add_u32 v8, v9, 5, v8
    v_and_b32 v9, 3, v0
    v_lshl_add_u32 v116, v9, 3, v8
    v_lshrrev_b32 v6, 3, v0
    v_and_b32 v7, 7, v0
    v_bfe_u32 v8, v6, 1, 1
    v_lshlrev_b32 v8, 2, v8
    v_xor_b32 v8, v7, v8
    v_lshlrev_b32 v9, 10, v6
    v_lshl_add_u32 v117, v8, 4, v9
    s_call_b64 s[52:53], L_setup
    s_setprio 3
    v_mfma_f32_32x32x8_bf16 v[60:75], v[22:23], v[22:23], 0
    v_add_u32 v21, 81920, v124
    v_xor_b32 v22, 32, v21
    v_xor_b32 v23, 64, v21
    v_xor_b32 v24, 96, v21
    v_add_u32 v25, 90112, v116
    s_mov_b32 s86, 6
    s_mov_b32 s84, 1
    s_barrier
L_Qloop:
    s_barrier
    ds_read_b128 v[76:79], v21 offset:0
    ds_read_b64_tr_b16 v[80:81], v25 offset:0
    ds_read_b64_tr_b16 v[82:83], v25 offset:512
    ds_read_b128 v[84:87], v22 offset:0
    ds_read_b64_tr_b16 v[88:89], v25 offset:2048
    ds_read_b64_tr_b16 v[90:91], v25 offset:2560
    ds_read_b128 v[44:47], v23 offset:0
    ds_read_b64_tr_b16 v[48:49], v25 offset:4096
    ds_read_b64_tr_b16 v[50:51], v25 offset:4608
    ds_read_b128 v[52:55], v24 offset:0
    ds_read_b64_tr_b16 v[56:57], v25 offset:6144
    ds_read_b64_tr_b16 v[58:59], v25 offset:6656
    s_add_u32 s84, s84, 1
    s_cmp_eq_u32 s84, 3
    s_cselect_b32 s84, 0, s84
    s_mov_b32 s87, 49152
    s_cselect_b32 s87, -98304, s87
    v_add_u32 v21, s87, v21
    v_add_u32 v22, s87, v22
    v_add_u32 v23, s87, v23
    v_add_u32 v24, s87, v24
    v_add_u32 v25, s87, v25
    s_sub_u32 s86, s86, 1
    s_cmp_lg_u32 s86, 0
    s_waitcnt lgkmcnt(9)
    v_mfma_f32_32x32x16_bf16 v[60:75], v[80:83], v[76:79], v[60:75]
    s_waitcnt lgkmcnt(6)
    v_mfma_f32_32x32x16_bf16 v[60:75], v[88:91], v[84:87], v[60:75]
    s_waitcnt lgkmcnt(3)
    v_mfma_f32_32x32x16_bf16 v[60:75], v[48:51], v[44:47], v[60:75]
    s_waitcnt lgkmcnt(0)
    v_mfma_f32_32x32x16_bf16 v[60:75], v[56:59], v[52:55], v[60:75]
    s_cbranch_scc1 L_Qloop
    s_mov_b32 s86, 8
    s_mov_b32 s62, 163684
    s_movk_i32 s60, 0x2014
    s_mov_b32 s63, 0xff1c1810
    v_mov_b32 v27, 163696
    s_mov_b32 s59, 98304
    s_mov_b32 s90, 8
    s_mov_b32 s58, 16
    s_mov_b32 s84, 0
    s_mov_b32 s85, 1
    s_mov_b32 s87, 98304
    v_add_u32 v26, s87, v119
    v_mad_u32_u24 v12, v14, s87, v13
    s_min_u32 s87, s85, 32
    s_lshl_b32 s87, s87, 12
    s_add_u32 s87, s87, s59
    v_add_u32 v1, s87, v119
    v_mad_u32_u24 v2, v14, s87, v13
    v_mov_b32 v4, 0
    v_mov_b32 v5, 0
    s_mov_b32 s88, 0x3eb8aa3b
    s_mov_b32 s89, s88
    s_barrier
    ds_read_b128 v[76:79], v21 offset:0
    ds_read_b64_tr_b16 v[80:81], v25 offset:0
    ds_read_b64_tr_b16 v[82:83], v25 offset:512
    ds_read_b128 v[84:87], v22 offset:0
    ds_read_b64_tr_b16 v[88:89], v25 offset:2048
    ds_read_b64_tr_b16 v[90:91], v25 offset:2560
    ds_read_b128 v[44:47], v23 offset:0
    ds_read_b64_tr_b16 v[48:49], v25 offset:4096
    ds_read_b64_tr_b16 v[50:51], v25 offset:4608
    ds_read_b128 v[52:55], v24 offset:0
    ds_read_b64_tr_b16 v[56:57], v25 offset:6144
    ds_read_b64_tr_b16 v[58:59], v25 offset:6656
    s_waitcnt lgkmcnt(9)
    v_mfma_f32_32x32x16_bf16 v[60:75], v[80:83], v[76:79], v[60:75]
    ds_read_b128 v[76:79], v21 offset:49152
    ds_read_b64_tr_b16 v[80:81], v25 offset:49152
    ds_read_b64_tr_b16 v[82:83], v25 offset:49664
    s_waitcnt lgkmcnt(9)
    v_mfma_f32_32x32x16_bf16 v[60:75], v[88:91], v[84:87], v[60:75]
    ds_read_b128 v[84:87], v22 offset:49152
    ds_read_b64_tr_b16 v[88:89], v25 offset:51200
    ds_read_b64_tr_b16 v[90:91], v25 offset:51712
    s_waitcnt lgkmcnt(9)
    v_mfma_f32_32x32x16_bf16 v[60:75], v[48:51], v[44:47], v[60:75]
    ds_read_b128 v[44:47], v23 offset:49152
    ds_read_b64_tr_b16 v[48:49], v25 offset:53248
    ds_read_b64_tr_b16 v[50:51], v25 offset:53760
    s_waitcnt lgkmcnt(9)
    v_mfma_f32_32x32x16_bf16 v[60:75], v[56:59], v[52:55], v[60:75]
    ds_read_b128 v[52:55], v24 offset:49152
    ds_read_b64_tr_b16 v[56:57], v25 offset:55296
    ds_read_b64_tr_b16 v[58:59], v25 offset:55808
    ds_read_b32 v6, v118 offset:96
    s_mov_b64 exec, 1
    ds_add_u32 v118, v121 offset:76
    s_mov_b64 exec, -1
    s_waitcnt lgkmcnt(11)
    v_mfma_f32_32x32x16_bf16 v[60:75], v[80:83], v[76:79], v[60:75]
    s_waitcnt lgkmcnt(8)
    v_mfma_f32_32x32x16_bf16 v[60:75], v[88:91], v[84:87], v[60:75]
    s_waitcnt lgkmcnt(5)
    v_mfma_f32_32x32x16_bf16 v[60:75], v[48:51], v[44:47], v[60:75]
    s_waitcnt lgkmcnt(2)
    v_mfma_f32_32x32x16_bf16 v[60:75], v[56:59], v[52:55], v[60:75]
    s_waitcnt lgkmcnt(0)
    v_mfma_f32_32x32x8_bf16 v[44:59], v[4:5], v[4:5], 0
    v_readfirstlane_b32 s87, v6
    s_mov_b64 exec, 1
    ds_add_u32 v118, v121 offset:84
    s_mov_b64 exec, -1
    s_cmp_ge_u32 s87, 4
    s_cbranch_scc1 L_krdy
    s_mov_b32 s94, 163680
    s_mov_b32 s95, 4
    s_call_b64 s[56:57], L_waitf
L_krdy:
    ds_read_b128 v[92:95], v26
    ds_read_b128 v[100:103], v12 offset:0
    ds_read_b128 v[104:107], v12 offset:512
    ds_read_b128 v[96:99], v26 offset:1024
    s_nop 0
    v_pk_mul_f32 v[60:61], v[60:61], s[88:89]
    v_pk_mul_f32 v[62:63], v[62:63], s[88:89]
    v_pk_mul_f32 v[64:65], v[64:65], s[88:89]
    v_pk_mul_f32 v[66:67], v[66:67], s[88:89]
    v_pk_mul_f32 v[68:69], v[68:69], s[88:89]
    v_pk_mul_f32 v[70:71], v[70:71], s[88:89]
    v_pk_mul_f32 v[72:73], v[72:73], s[88:89]
    v_pk_mul_f32 v[74:75], v[74:75], s[88:89]
    v_cvt_pk_bf16_f32 v4, v60, v61
    v_cvt_pk_bf16_f32 v5, v62, v63
    v_cvt_pk_bf16_f32 v6, v64, v65
    v_cvt_pk_bf16_f32 v7, v66, v67
    v_cvt_pk_bf16_f32 v8, v68, v69
    v_cvt_pk_bf16_f32 v9, v70, v71
    v_cvt_pk_bf16_f32 v10, v72, v73
    v_cvt_pk_bf16_f32 v11, v74, v75
    ds_write_b128 v20, v[4:7]
    ds_write_b128 v20, v[8:11] offset:1024
    s_mov_b64 exec, 1
    ds_add_u32 v118, v121 offset:56
    s_mov_b64 exec, -1
    s_waitcnt lgkmcnt(3)
    s_branch L_go2
L_go:
    s_waitcnt lgkmcnt(0)
L_go2:
    v_mfma_f32_32x32x16_bf16 v[60:75], v[92:95], v[4:7], 0
    s_setprio 2
    s_nop 9
    s_branch L_go3
L_start:
    s_mov_b32 s86, 0
    s_mov_b32 s84, 0
    s_mov_b32 s62, 163680
    s_mov_b32 s60, 0x201408
    s_mov_b32 s63, 0xff1c1810
    v_mov_b32 v27, 163696
    s_mov_b32 s58, 16
    s_cmp_ge_u32 s85, 32
    s_cbranch_scc1 L_nowork
    s_call_b64 s[52:53], L_rare
    s_min_u32 s87, s85, 32
    s_lshl_b32 s87, s87, 12
    s_add_u32 s87, s87, s59
    v_add_u32 v1, s87, v119
    v_mad_u32_u24 v2, v14, s87, v13
    ds_read_b128 v[92:95], v1 offset:0
    ds_read_b128 v[100:103], v2 offset:0
    ds_read_b128 v[104:107], v2 offset:512
    ds_read_b128 v[96:99], v1 offset:1024
    v_mov_b32 v12, v2
    s_mov_b32 s84, s85
    s_add_u32 s85, s85, 1
    s_waitcnt lgkmcnt(3)
    v_mfma_f32_32x32x16_bf16 v[60:75], v[92:95], v[4:7], 0
    s_setprio 2
    s_call_b64 s[52:53], L_retire
    s_call_b64 s[52:53], L_rare
    s_min_u32 s87, s85, 32
    s_lshl_b32 s87, s87, 12
    s_add_u32 s87, s87, s59
    v_add_u32 v1, s87, v119
    v_mad_u32_u24 v2, v14, s87, v13
L_go3:
    v_exp_f32 v60, v60
    v_exp_f32 v61, v61
    s_branch L_entry
.p2align 4
L_loop:
    v_exp_f32 v60, v60
    v_exp_f32 v61, v61
    v_smfmac_f32_32x32x32_bf16 v[44:59], v[112:115], v[84:91], v3
L_entry:
    s_mov_b64 exec, 1
    ds_add_rtn_u32 v16, v15, v121
    s_mov_b64 exec, -1
    ds_read_b128 v[108:111], v12 offset:1024
    ds_read_b128 v[112:115], v12 offset:1536
    v_exp_f32 v62, v62
    v_exp_f32 v63, v63
    v_exp_f32 v64, v64
    v_mfma_f32_32x32x16_bf16 v[76:91], v[92:95], v[8:11], 0
    ds_read_b128 v[92:95], v1 offset:0
    v_exp_f32 v65, v65
    v_exp_f32 v66, v66
    v_exp_f32 v67, v67
    v_exp_f32 v68, v68
    v_exp_f32 v69, v69
    s_waitcnt lgkmcnt(3)
    v_smfmac_f32_32x32x32_bf16 v[28:43], v[100:103], v[60:67], v3
    v_exp_f32 v70, v70
    v_exp_f32 v71, v71
    v_exp_f32 v72, v72
    v_exp_f32 v73, v73
    v_exp_f32 v74, v74
    v_exp_f32 v75, v75
    v_exp_f32 v76, v76
    v_exp_f32 v77, v77
    v_smfmac_f32_32x32x32_bf16 v[28:43], v[104:107], v[68:75], v3
    v_exp_f32 v78, v78
    v_exp_f32 v79, v79
    v_exp_f32 v80, v80
    v_mfma_f32_32x32x16_bf16 v[60:75], v[96:99], v[4:7], 0
    v_exp_f32 v81, v81
    v_exp_f32 v82, v82
    v_exp_f32 v83, v83
    v_exp_f32 v84, v84
    v_exp_f32 v85, v85
    v_smfmac_f32_32x32x32_bf16 v[44:59], v[100:103], v[76:83], v3
    v_exp_f32 v86, v86
    v_exp_f32 v87, v87
    v_exp_f32 v88, v88
    v_exp_f32 v89, v89
    v_exp_f32 v90, v90
    v_exp_f32 v91, v91
    v_exp_f32 v60, v60
    v_exp_f32 v61, v61
    v_smfmac_f32_32x32x32_bf16 v[44:59], v[104:107], v[84:91], v3
    ds_read_b128 v[100:103], v2 offset:0
    ds_read_b128 v[104:107], v2 offset:512
    v_exp_f32 v62, v62
    v_exp_f32 v63, v63
    v_exp_f32 v64, v64
    v_mfma_f32_32x32x16_bf16 v[76:91], v[96:99], v[8:11], 0
    ds_read_b128 v[96:99], v1 offset:1024
    v_exp_f32 v65, v65
    v_exp_f32 v66, v66
    v_exp_f32 v67, v67
    v_exp_f32 v68, v68
    v_exp_f32 v69, v69
    s_waitcnt lgkmcnt(3)
    v_smfmac_f32_32x32x32_bf16 v[28:43], v[108:111], v[60:67], v3
    s_mov_b32 s84, s85
    v_readfirstlane_b32 s85, v16
    v_mov_b32 v12, v2
    v_exp_f32 v70, v70
    v_exp_f32 v71, v71
    v_exp_f32 v72, v72
    s_cmp_ge_u32 s84, s58
    s_cbranch_scc1 L_retj
L_retr:
    v_exp_f32 v73, v73
    v_exp_f32 v74, v74
    v_exp_f32 v75, v75
    v_exp_f32 v76, v76
    v_exp_f32 v77, v77
    v_smfmac_f32_32x32x32_bf16 v[28:43], v[112:115], v[68:75], v3
    s_cmp_ge_u32 s85, s90
    s_cbranch_scc1 L_rarej
L_rarer:
    v_exp_f32 v78, v78
    v_exp_f32 v79, v79
    v_exp_f32 v80, v80
    v_mfma_f32_32x32x16_bf16 v[60:75], v[92:95], v[4:7], 0
    s_min_u32 s87, s85, 32
    s_lshl_b32 s87, s87, 12
    s_add_u32 s87, s87, s59
    v_add_u32 v1, s87, v119
    v_mad_u32_u24 v2, v14, s87, v13
    v_exp_f32 v81, v81
    v_exp_f32 v82, v82
    v_exp_f32 v83, v83
    v_exp_f32 v84, v84
    v_exp_f32 v85, v85
    v_smfmac_f32_32x32x32_bf16 v[44:59], v[108:111], v[76:83], v3
    s_cmp_lt_u32 s84, 32
    v_exp_f32 v86, v86
    v_exp_f32 v87, v87
    v_exp_f32 v88, v88
    v_exp_f32 v89, v89
    v_exp_f32 v90, v90
    v_exp_f32 v91, v91
    s_cbranch_scc1 L_loop
    s_setprio 3
    v_smfmac_f32_32x32x32_bf16 v[44:59], v[112:115], v[84:91], v3
L_adone:
    s_mov_b64 exec, 1
    ds_add_rtn_u32 v120, v17, v121 offset:0
    s_mov_b64 exec, -1
    ds_read_b32 v122, v17 offset:16
    ds_read_b128 v[92:95], v18 offset:0
    ds_read_b128 v[96:99], v18 offset:1024
    ds_read_b128 v[100:103], v18 offset:2048
    ds_read_b128 v[104:107], v18 offset:3072
    ds_read2st64_b32 v[22:23], v19 offset0:0 offset1:1
    s_add_u32 s88, s61, 4194304
    s_waitcnt lgkmcnt(0)
    v_readfirstlane_b32 s84, v120
    v_readfirstlane_b32 s85, v122
    s_nop 0
    s_cmp_eq_u32 s84, 0
    s_cbranch_scc1 L_wr0
    s_cmp_eq_u32 s84, s85
    s_cbranch_scc1 L_add
    s_lshl2_add_u32 s94, s46, 163600
    s_mov_b32 s95, s84
    s_call_b64 s[56:57], L_waitf
    ds_read_b128 v[92:95], v18 offset:0
    ds_read_b128 v[96:99], v18 offset:1024
    ds_read_b128 v[100:103], v18 offset:2048
    ds_read_b128 v[104:107], v18 offset:3072
    ds_read2st64_b32 v[22:23], v19 offset0:0 offset1:1
    s_waitcnt lgkmcnt(0)
L_add:
    v_pk_add_f32 v[28:29], v[28:29], v[92:93]
    v_pk_add_f32 v[30:31], v[30:31], v[94:95]
    v_pk_add_f32 v[32:33], v[32:33], v[96:97]
    v_pk_add_f32 v[34:35], v[34:35], v[98:99]
    v_pk_add_f32 v[44:45], v[44:45], v[100:101]
    v_pk_add_f32 v[46:47], v[46:47], v[102:103]
    v_pk_add_f32 v[48:49], v[48:49], v[104:105]
    v_pk_add_f32 v[50:51], v[50:51], v[106:107]
    v_add_f32 v36, v36, v22
    v_add_f32 v52, v52, v23
    s_cmp_eq_u32 s84, 2
    s_cbranch_scc1 L_last
    s_branch L_wr
L_wr0:
    s_mov_b32 s94, 163656
    s_mov_b32 s95, 4
    s_call_b64 s[56:57], L_waits
L_wr:
    ds_write_b128 v18, v[28:31]
    ds_write_b128 v18, v[32:35] offset:1024
    ds_write_b128 v18, v[44:47] offset:2048
    ds_write_b128 v18, v[48:51] offset:3072
    ds_write2st64_b32 v19, v36, v52 offset0:0 offset1:1
    s_mov_b64 exec, 1
    ds_add_u32 v17, v121 offset:16
    s_mov_b64 exec, -1
    s_branch L_role
L_nowork:
    s_mov_b32 s84, 32
    s_call_b64 s[52:53], L_retire
    s_setprio 3
    s_branch L_adone
L_last:
    v_pk_add_f32 v[92:93], v[28:29], v[44:45]
    v_pk_add_f32 v[94:95], v[30:31], v[46:47]
    v_pk_add_f32 v[96:97], v[32:33], v[48:49]
    v_pk_add_f32 v[98:99], v[34:35], v[50:51]
    v_min_f32 v60, v36, v52
    v_max_f32 v61, v36, v52
    v_pk_add_f32 v[92:93], v[92:93], v[94:95]
    v_pk_add_f32 v[96:97], v[96:97], v[98:99]
    v_cmp_nle_f32 vcc, 0x26800000, v60
    v_pk_add_f32 v[92:93], v[92:93], v[96:97]
    s_mov_b64 s[84:85], vcc
    v_cmp_nge_f32 vcc, 0x71800000, v61
    v_add_f32 v92, v92, v93
    v_mov_b32 v93, 0x207
    s_or_b64 s[84:85], s[84:85], vcc
    v_cmp_class_f32 vcc, v92, v93
    v_mov_b32 v60, v36
    v_mov_b32 v61, v52
    s_or_b64 s[84:85], s[84:85], vcc
    s_cbranch_scc1 L_fallback
L_norm:
    s_call_b64 s[52:53], L_normstore
L_role:
    s_cmp_eq_u32 s47, 0
    s_cbranch_scc1 L_out
    s_barrier
    s_branch L_fin
L_out:
    s_mov_b64 s[32:33], s[80:81]
    s_mov_b32 s34, 0x400000
    s_mov_b32 s35, 0x20000
    s_mov_b32 s14, 0x80000
    s_mov_b32 s15, 0x20000
    s_waitcnt vmcnt(0)
    s_lshl_b32 s87, s44, 6
    v_xor_b32 v2, s87, v116
    s_lshl1_add_u32 s62, s41, s43
    s_lshl1_add_u32 s62, s62, s44
    s_lshl_b32 s62, s62, 14
    s_cmp_eq_u32 s47, 3
    s_cbranch_scc1 L_outA
    s_mov_b64 s[12:13], s[78:79]
    s_lshl_b32 s87, s44, 15
    s_add_u32 s87, s87, 32768
    v_add_u32 v2, s87, v2
    v_xor_b32 v3, 64, v2
    s_add_u32 s64, s62, 4194304
    s_add_u32 s65, s62, 4198400
    s_add_u32 s66, s62, 4202496
    s_add_u32 s67, s62, 4206592
    s_mov_b32 s86, 131072
    s_movk_i32 s85, 1024
    s_mov_b32 s84, 163636
    s_call_b64 s[52:53], L_prep
    s_mov_b32 s60, 1
    s_lshr_b32 s88, s46, 1
    s_add_u32 s88, s88, 2
    s_and_b32 s88, s88, 3
    s_lshl_b32 s88, s88, 16
    s_lshl_b32 s87, s44, 15
    s_add_u32 s88, s88, s87
    s_add_u32 s88, s88, 262144
    s_lshl_b32 s89, s46, 12
    s_add_u32 s89, s89, 81920
    s_lshl_b32 s87, s42, 7
    s_add_u32 s88, s88, s87
    s_waitcnt vmcnt(0)
    s_barrier
    s_add_u32 m0, s89, 0
    s_add_u32 s87, s88, 0
    buffer_load_dwordx4 v117, s[12:15], s87 offen lds
    s_add_u32 m0, s89, 1024
    s_add_u32 s87, s88, 8192
    buffer_load_dwordx4 v117, s[12:15], s87 offen lds
    s_add_u32 m0, s89, 2048
    s_add_u32 s87, s88, 16384
    buffer_load_dwordx4 v117, s[12:15], s87 offen lds
    s_add_u32 m0, s89, 3072
    s_add_u32 s87, s88, 24576
    buffer_load_dwordx4 v117, s[12:15], s87 offen lds
    s_call_b64 s[52:53], L_ogemm
    s_call_b64 s[52:53], L_epi
    s_branch L_fin
L_outA:
    s_mov_b64 s[12:13], s[68:69]
    s_cmp_eq_u32 s44, 0
    s_cselect_b32 s87, 98304, 0
    v_add_u32 v2, s87, v2
    v_xor_b32 v3, 64, v2
    s_mov_b32 s94, 163696
    s_mov_b32 s95, 12
    s_call_b64 s[56:57], L_waitl
    s_mul_i32 s88, s46, 65536
    s_add_u32 s88, s88, 0
    s_mul_i32 s89, s46, 8192
    s_add_u32 s89, s89, 98304
    s_mov_b32 s84, 8
    s_call_b64 s[52:53], L_wo
    s_mul_i32 s88, s46, 65536
    s_add_u32 s88, s88, 262144
    s_mul_i32 s89, s46, 8192
    s_add_u32 s89, s89, 0
    s_mov_b32 s84, 8
    s_call_b64 s[52:53], L_wo
    s_lshl_b32 s87, s41, 9
    s_add_u32 s87, s87, 32768
    s_mov_b64 exec, 0xffffffff
    s_mov_b32 s96, 0
L_pf5:
    buffer_load_dword v120, v119, s[36:39], s87 offen sc1
    s_add_u32 s96, s96, 1
    s_waitcnt vmcnt(0)
    v_cmp_ne_u32 vcc, s45, v120
    s_cmp_gt_u32 s96, 400000
    s_cbranch_scc1 L_pfx6
    s_cmp_eq_u64 vcc, 0
    s_cbranch_scc1 L_pfx6
    s_sleep 16
    s_branch L_pf5
L_pfx6:
    s_mov_b64 exec, -1
    s_add_u32 s64, s62, 2097152
    s_add_u32 s65, s62, 2101248
    s_add_u32 s66, s62, 2105344
    s_add_u32 s67, s62, 2109440
    s_call_b64 s[52:53], L_oload
    s_mov_b32 s86, 149504
    s_mov_b32 s85, 0
    s_mov_b32 s84, 163716
    s_mov_b32 s86, 0
    s_call_b64 s[52:53], L_prep
    s_mov_b64 s[12:13], s[78:79]
    s_lshr_b32 s88, s46, 0
    s_add_u32 s88, s88, 0
    s_and_b32 s88, s88, 3
    s_lshl_b32 s88, s88, 16
    s_lshl_b32 s89, s46, 13
    s_add_u32 s89, s89, 32768
    s_mov_b32 s84, 8
    s_mov_b32 s94, 163700
    s_mov_b32 s95, 12
    s_call_b64 s[56:57], L_waitl
    s_call_b64 s[52:53], L_wo
    s_lshr_b32 s88, s46, 1
    s_add_u32 s88, s88, 0
    s_and_b32 s88, s88, 3
    s_lshl_b32 s88, s88, 16
    s_lshl_b32 s87, s44, 15
    s_add_u32 s88, s88, s87
    s_add_u32 s88, s88, 262144
    s_lshl_b32 s89, s46, 12
    s_add_u32 s89, s89, 65536
    s_mov_b32 s84, 4
    s_mov_b32 s94, 163704
    s_mov_b32 s95, 12
    s_call_b64 s[56:57], L_waitl
    s_call_b64 s[52:53], L_wo
    s_mov_b32 s60, 0
    s_waitcnt vmcnt(0)
    s_barrier
    s_setprio 2
    s_call_b64 s[52:53], L_ogemm
    s_mov_b64 exec, 1
    ds_add_u32 v118, v121 offset:128
    s_mov_b64 exec, -1
    s_mov_b32 s94, 163712
    s_mov_b32 s95, 4
    s_call_b64 s[56:57], L_waitf
    s_call_b64 s[52:53], L_epi
L_fin:
    s_endpgm
L_waitf:
    v_mov_b32 v123, s94
    s_mov_b32 s96, 0
L_wlf:
    ds_read_b32 v120, v123
    s_add_u32 s96, s96, 1
    s_waitcnt lgkmcnt(0)
    v_readfirstlane_b32 s97, v120
    s_cmp_gt_u32 s96, 1600000
    s_cbranch_scc1 L_wxf
    s_cmp_ge_u32 s97, s95
    s_cbranch_scc1 L_wxf
    s_branch L_wlf
L_wxf:
    s_setpc_b64 s[56:57]
L_waits:
    v_mov_b32 v123, s94
    s_mov_b32 s96, 0
L_wls:
    ds_read_b32 v120, v123
    s_add_u32 s96, s96, 1
    s_waitcnt lgkmcnt(0)
    v_readfirstlane_b32 s97, v120
    s_cmp_gt_u32 s96, 1600000
    s_cbranch_scc1 L_wxs
    s_cmp_ge_u32 s97, s95
    s_cbranch_scc1 L_wxs
    s_sleep 1
    s_branch L_wls
L_wxs:
    s_setpc_b64 s[56:57]
L_waitl:
    v_mov_b32 v123, s94
    s_mov_b32 s96, 0
L_wll:
    ds_read_b32 v120, v123
    s_add_u32 s96, s96, 1
    s_waitcnt lgkmcnt(0)
    v_readfirstlane_b32 s97, v120
    s_cmp_gt_u32 s96, 1600000
    s_cbranch_scc1 L_wxl
    s_cmp_ge_u32 s97, s95
    s_cbranch_scc1 L_wxl
    s_sleep 8
    s_branch L_wll
L_wxl:
    s_setpc_b64 s[56:57]
L_setup:
    v_mov_b32 v22, 0
    v_mov_b32 v23, 0
    s_lshl2_add_u32 s87, s46, 163584
    v_mov_b32 v17, s87
    v_add_u32 v15, 224, v17
    v_mfma_f32_32x32x8_bf16 v[28:43], v[22:23], v[22:23], 0
    v_lshrrev_b32 v1, 5, v0
    v_lshlrev_b32 v1, 8, v1
    v_and_b32 v2, 15, v0
    v_lshl_add_u32 v1, v2, 4, v1
    v_add_u32 v1, 2048, v1
    s_mov_b32 s92, 0x0000ffff
    s_mov_b32 s93, 0x0000ffff
    s_mov_b32 s88, 0x00110000
    s_mov_b32 s89, 0x00110000
    v_mov_b32 v2, 157712
    v_mov_b32 v3, 157696
    v_cndmask_b32 v2, v2, v3, s[88:89]
    v_mfma_f32_32x32x8_bf16 v[44:59], v[22:23], v[22:23], 0
    v_cndmask_b32 v13, v2, v1, s[92:93]
    v_cndmask_b32 v14, 0, 1, s[92:93]
    v_mov_b32 v3, 0xdddddddd
    s_lshl_b32 s87, s46, 12
    s_add_u32 s87, s87, 131072
    v_add_u32 v18, s87, v119
    v_lshrrev_b32 v19, 2, v119
    s_lshl_b32 s87, s46, 9
    s_add_u32 s87, s87, 147456
    v_add_u32 v19, s87, v19
    v_add_u32 v20, 149504, v125
    s_lshl_b32 s87, s47, 3
    s_lshr_b32 s91, 0x2020201c, s87
    s_and_b32 s91, s91, 0xff
    s_lshl1_add_u32 s61, s41, s43
    s_lshl3_add_u32 s61, s61, s42
    s_lshl1_add_u32 s61, s61, s44
    s_lshl_b32 s61, s61, 11
    s_setpc_b64 s[52:53]
L_rarej:
    s_call_b64 s[52:53], L_rare
    s_branch L_rarer
L_retj:
    s_call_b64 s[52:53], L_retire
    s_branch L_retr
L_rare:
    s_cmp_lt_u32 s85, 8
    s_mov_b32 s59, -32768
    s_cselect_b32 s59, 98304, s59
    s_cmp_lt_u32 s85, s91
    s_cbranch_scc1 L_ra5
    v_mov_b32 v15, 163824
    s_movk_i32 s91, 0x7fff
L_ra5:
    s_cmp_lt_u32 s85, s86
    s_cbranch_scc1 L_ra3
    s_mov_b32 s94, s62
    s_add_u32 s62, s62, 4
    s_and_b32 s86, s60, 0xff
    s_lshr_b32 s60, s60, 8
    s_cmp_eq_u32 s86, 32
    s_cselect_b32 s86, 0x7fff, s86
    s_cmp_ge_u32 s85, s86
    s_cbranch_scc1 L_ra5
    s_mov_b32 s95, 4
    s_call_b64 s[56:57], L_waitf
L_ra3:
    s_min_u32 s90, s86, s91
    s_setpc_b64 s[52:53]
L_retire:
    s_cmp_lt_u32 s84, s58
    s_cbranch_scc1 L_ret1
    s_mov_b64 exec, 1
    ds_add_u32 v27, v121 offset:0
    s_mov_b64 exec, -1
    v_add_u32 v27, 4, v27
    s_ashr_i32 s63, s63, 8
    s_setprio 1
    s_cmp_eq_u32 s58, 16
    s_cbranch_scc1 L_ret2
    s_setprio 0
L_ret2:
    s_and_b32 s58, s63, 0xff
    s_branch L_retire
L_ret1:
    s_setpc_b64 s[52:53]
L_issueK:
    s_mov_b32 m0, s62
    s_add_u32 s88, s62, s54
    s_and_b32 s88, s88, 0x1ffff
    s_add_u32 s88, s88, 65536
    s_waitcnt vmcnt(1)
    buffer_load_dwordx4 v119, s[36:39], s88 offen offset:0 sc1 lds
    s_waitcnt vmcnt(1)
    buffer_load_dwordx4 v119, s[36:39], s88 offen offset:1024 sc1 lds
    s_waitcnt vmcnt(1)
    buffer_load_dwordx4 v119, s[36:39], s88 offen offset:2048 sc1 lds
    s_waitcnt vmcnt(1)
    buffer_load_dwordx4 v119, s[36:39], s88 offen offset:3072 sc1 lds
    s_add_u32 s62, s62, 16384
    s_sub_u32 s89, s89, 1
    s_cmp_lg_u32 s89, 0
    s_cbranch_scc1 L_issueK
    s_setpc_b64 s[52:53]
L_wo:
    s_lshl_b32 s87, s42, 7
    s_add_u32 s88, s88, s87
L_wol:
    s_mov_b32 m0, s89
    s_add_u32 s89, s89, 1024
    s_waitcnt vmcnt(2)
    buffer_load_dwordx4 v117, s[12:15], s88 offen lds
    s_add_u32 s88, s88, 8192
    s_sub_u32 s84, s84, 1
    s_cmp_lg_u32 s84, 0
    s_cbranch_scc1 L_wol
    s_setpc_b64 s[52:53]
L_prep:
    v_mov_b32 v4, 0
    v_mov_b32 v5, 0
    v_mov_b32 v126, s84
    s_xor_b32 s87, s46, 1
    s_lshl_b32 s87, s87, 12
    s_add_u32 s87, s87, s86
    v_add_u32 v124, s87, v119
    v_mfma_f32_32x32x8_bf16 v[12:27], v[4:5], v[4:5], 0
    s_lshl_b32 s87, s46, 12
    s_add_u32 s87, s87, s86
    v_add_u32 v125, s87, v119
    v_and_b32 v6, 31, v0
    v_lshrrev_b32 v7, 5, v0
    v_lshlrev_b32 v1, 11, v6
    v_lshl_add_u32 v1, v7, 4, v1
    v_mfma_f32_32x32x8_bf16 v[28:43], v[4:5], v[4:5], 0
    s_lshl_b32 s61, s41, 17
    s_lshl_b32 s87, s43, 16
    s_add_u32 s61, s61, s87
    s_add_u32 s61, s61, s85
    s_lshl_b32 s87, s42, 7
    s_add_u32 s61, s61, s87
    s_lshl_b32 s87, s44, 6
    s_add_u32 s61, s61, s87
    s_mov_b32 s59, s84
    s_setpc_b64 s[52:53]
L_ogemm:
    s_mov_b32 s96, 0
    s_mov_b32 s84, 0
    s_cmp_eq_u32 s60, 0
    s_cbranch_scc1 L_og1
    buffer_load_dwordx4 v[48:51], v119, s[36:39], s64 offen offset:0 sc1
    buffer_load_dwordx4 v[52:55], v119, s[36:39], s64 offen offset:1024 sc1
    buffer_load_dwordx4 v[56:59], v119, s[36:39], s64 offen offset:2048 sc1
    buffer_load_dwordx4 v[60:63], v119, s[36:39], s64 offen offset:3072 sc1
    buffer_load_dwordx4 v[64:67], v119, s[36:39], s65 offen offset:0 sc1
    buffer_load_dwordx4 v[68:71], v119, s[36:39], s65 offen offset:1024 sc1
    buffer_load_dwordx4 v[72:75], v119, s[36:39], s65 offen offset:2048 sc1
    buffer_load_dwordx4 v[76:79], v119, s[36:39], s65 offen offset:3072 sc1
    buffer_load_dwordx4 v[80:83], v119, s[36:39], s66 offen offset:0 sc1
    buffer_load_dwordx4 v[84:87], v119, s[36:39], s66 offen offset:1024 sc1
    buffer_load_dwordx4 v[88:91], v119, s[36:39], s66 offen offset:2048 sc1
    buffer_load_dwordx4 v[92:95], v119, s[36:39], s66 offen offset:3072 sc1
    buffer_load_dwordx4 v[96:99], v119, s[36:39], s67 offen offset:0 sc1
    buffer_load_dwordx4 v[100:103], v119, s[36:39], s67 offen offset:1024 sc1
    buffer_load_dwordx4 v[104:107], v119, s[36:39], s67 offen offset:2048 sc1
    buffer_load_dwordx4 v[108:111], v119, s[36:39], s67 offen offset:3072 sc1
L_og1:
    ds_read_b64_tr_b16 v[4:5], v2 offset:0
    ds_read_b64_tr_b16 v[6:7], v2 offset:512
    ds_read_b64_tr_b16 v[8:9], v3 offset:0
    ds_read_b64_tr_b16 v[10:11], v3 offset:512
    ds_read_b64_tr_b16 v[44:45], v2 offset:2048
    ds_read_b64_tr_b16 v[46:47], v2 offset:2560
    ds_read_b64_tr_b16 v[112:113], v3 offset:2048
    ds_read_b64_tr_b16 v[114:115], v3 offset:2560
    s_cmp_eq_u32 s60, 0
    s_cbranch_scc1 L_ok7
    s_waitcnt vmcnt(12)
    s_mov_b64 exec, 1
    ds_add_u32 v118, v121 offset:40
    s_mov_b64 exec, -1
    s_waitcnt lgkmcnt(0)
    v_max3_u32 v120, v48, v49, v50
    v_max3_u32 v122, v51, v52, v53
    v_max3_u32 v120, v54, v55, v120
    v_max3_u32 v122, v56, v57, v122
    v_max3_u32 v120, v58, v59, v120
    v_max3_u32 v122, v60, v61, v122
    v_max3_u32 v120, v62, v63, v120
    v_max_u32 v120, v120, v122
    v_cmp_eq_u32 vcc, -1, v120
    s_cmp_eq_u64 vcc, 0
    s_cbranch_scc1 L_ok7
    s_bitset1_b32 s84, 0
    buffer_load_dwordx4 v[48:51], v119, s[36:39], s64 offen offset:0 sc1
    buffer_load_dwordx4 v[52:55], v119, s[36:39], s64 offen offset:1024 sc1
    buffer_load_dwordx4 v[56:59], v119, s[36:39], s64 offen offset:2048 sc1
    buffer_load_dwordx4 v[60:63], v119, s[36:39], s64 offen offset:3072 sc1
    ds_read_b64_tr_b16 v[4:5], v2 offset:8192
    ds_read_b64_tr_b16 v[6:7], v2 offset:8704
    ds_read_b64_tr_b16 v[8:9], v3 offset:8192
    ds_read_b64_tr_b16 v[10:11], v3 offset:8704
    ds_read_b64_tr_b16 v[44:45], v2 offset:10240
    ds_read_b64_tr_b16 v[46:47], v2 offset:10752
    ds_read_b64_tr_b16 v[112:113], v3 offset:10240
    ds_read_b64_tr_b16 v[114:115], v3 offset:10752
    s_branch L_nx8
L_ok7:
    s_waitcnt lgkmcnt(6)
    v_mfma_f32_32x32x16_bf16 v[12:27], v[4:7], v[48:51], v[12:27]
    ds_read_b64_tr_b16 v[4:5], v2 offset:4096
    ds_read_b64_tr_b16 v[6:7], v2 offset:4608
    s_waitcnt lgkmcnt(6)
    v_mfma_f32_32x32x16_bf16 v[28:43], v[8:11], v[48:51], v[28:43]
    ds_read_b64_tr_b16 v[8:9], v3 offset:4096
    ds_read_b64_tr_b16 v[10:11], v3 offset:4608
    s_waitcnt lgkmcnt(6)
    v_mfma_f32_32x32x16_bf16 v[12:27], v[44:47], v[52:55], v[12:27]
    ds_read_b64_tr_b16 v[44:45], v2 offset:6144
    ds_read_b64_tr_b16 v[46:47], v2 offset:6656
    s_waitcnt lgkmcnt(6)
    v_mfma_f32_32x32x16_bf16 v[28:43], v[112:115], v[52:55], v[28:43]
    ds_read_b64_tr_b16 v[112:113], v3 offset:6144
    ds_read_b64_tr_b16 v[114:115], v3 offset:6656
    s_waitcnt lgkmcnt(6)
    v_mfma_f32_32x32x16_bf16 v[12:27], v[4:7], v[56:59], v[12:27]
    ds_read_b64_tr_b16 v[4:5], v2 offset:8192
    ds_read_b64_tr_b16 v[6:7], v2 offset:8704
    s_waitcnt lgkmcnt(6)
    v_mfma_f32_32x32x16_bf16 v[28:43], v[8:11], v[56:59], v[28:43]
    ds_read_b64_tr_b16 v[8:9], v3 offset:8192
    ds_read_b64_tr_b16 v[10:11], v3 offset:8704
    s_waitcnt lgkmcnt(6)
    v_mfma_f32_32x32x16_bf16 v[12:27], v[44:47], v[60:63], v[12:27]
    ds_read_b64_tr_b16 v[44:45], v2 offset:10240
    ds_read_b64_tr_b16 v[46:47], v2 offset:10752
    s_waitcnt lgkmcnt(6)
    v_mfma_f32_32x32x16_bf16 v[28:43], v[112:115], v[60:63], v[28:43]
    ds_read_b64_tr_b16 v[112:113], v3 offset:10240
    ds_read_b64_tr_b16 v[114:115], v3 offset:10752
L_nx8:
    s_cmp_eq_u32 s60, 0
    s_cbranch_scc1 L_ok9
    s_waitcnt vmcnt(8)
    v_max3_u32 v120, v64, v65, v66
    v_max3_u32 v122, v67, v68, v69
    v_max3_u32 v120, v70, v71, v120
    v_max3_u32 v122, v72, v73, v122
    v_max3_u32 v120, v74, v75, v120
    v_max3_u32 v122, v76, v77, v122
    v_max3_u32 v120, v78, v79, v120
    v_max_u32 v120, v120, v122
    v_cmp_eq_u32 vcc, -1, v120
    s_mov_b32 s94, 163624
    s_mov_b32 s95, 4
    s_call_b64 s[56:57], L_waitf
    s_cmp_eq_u64 vcc, 0
    s_cbranch_scc1 L_ok9
    s_bitset1_b32 s84, 1
    buffer_load_dwordx4 v[64:67], v119, s[36:39], s65 offen offset:0 sc1
    buffer_load_dwordx4 v[68:71], v119, s[36:39], s65 offen offset:1024 sc1
    buffer_load_dwordx4 v[72:75], v119, s[36:39], s65 offen offset:2048 sc1
    buffer_load_dwordx4 v[76:79], v119, s[36:39], s65 offen offset:3072 sc1
    ds_read_b64_tr_b16 v[4:5], v2 offset:16384
    ds_read_b64_tr_b16 v[6:7], v2 offset:16896
    ds_read_b64_tr_b16 v[8:9], v3 offset:16384
    ds_read_b64_tr_b16 v[10:11], v3 offset:16896
    ds_read_b64_tr_b16 v[44:45], v2 offset:18432
    ds_read_b64_tr_b16 v[46:47], v2 offset:18944
    ds_read_b64_tr_b16 v[112:113], v3 offset:18432
    ds_read_b64_tr_b16 v[114:115], v3 offset:18944
    s_branch L_nx10
L_ok9:
    s_waitcnt lgkmcnt(6)
    v_mfma_f32_32x32x16_bf16 v[12:27], v[4:7], v[64:67], v[12:27]
    ds_read_b64_tr_b16 v[4:5], v2 offset:12288
    ds_read_b64_tr_b16 v[6:7], v2 offset:12800
    s_waitcnt lgkmcnt(6)
    v_mfma_f32_32x32x16_bf16 v[28:43], v[8:11], v[64:67], v[28:43]
    ds_read_b64_tr_b16 v[8:9], v3 offset:12288
    ds_read_b64_tr_b16 v[10:11], v3 offset:12800
    s_waitcnt lgkmcnt(6)
    v_mfma_f32_32x32x16_bf16 v[12:27], v[44:47], v[68:71], v[12:27]
    ds_read_b64_tr_b16 v[44:45], v2 offset:14336
    ds_read_b64_tr_b16 v[46:47], v2 offset:14848
    s_waitcnt lgkmcnt(6)
    v_mfma_f32_32x32x16_bf16 v[28:43], v[112:115], v[68:71], v[28:43]
    ds_read_b64_tr_b16 v[112:113], v3 offset:14336
    ds_read_b64_tr_b16 v[114:115], v3 offset:14848
    s_waitcnt lgkmcnt(6)
    v_mfma_f32_32x32x16_bf16 v[12:27], v[4:7], v[72:75], v[12:27]
    ds_read_b64_tr_b16 v[4:5], v2 offset:16384
    ds_read_b64_tr_b16 v[6:7], v2 offset:16896
    s_waitcnt lgkmcnt(6)
    v_mfma_f32_32x32x16_bf16 v[28:43], v[8:11], v[72:75], v[28:43]
    ds_read_b64_tr_b16 v[8:9], v3 offset:16384
    ds_read_b64_tr_b16 v[10:11], v3 offset:16896
    s_waitcnt lgkmcnt(6)
    v_mfma_f32_32x32x16_bf16 v[12:27], v[44:47], v[76:79], v[12:27]
    ds_read_b64_tr_b16 v[44:45], v2 offset:18432
    ds_read_b64_tr_b16 v[46:47], v2 offset:18944
    s_waitcnt lgkmcnt(6)
    v_mfma_f32_32x32x16_bf16 v[28:43], v[112:115], v[76:79], v[28:43]
    ds_read_b64_tr_b16 v[112:113], v3 offset:18432
    ds_read_b64_tr_b16 v[114:115], v3 offset:18944
L_nx10:
    s_cmp_eq_u32 s60, 0
    s_cbranch_scc1 L_ok11
    s_waitcnt vmcnt(4)
    v_max3_u32 v120, v80, v81, v82
    v_max3_u32 v122, v83, v84, v85
    v_max3_u32 v120, v86, v87, v120
    v_max3_u32 v122, v88, v89, v122
    v_max3_u32 v120, v90, v91, v120
    v_max3_u32 v122, v92, v93, v122
    v_max3_u32 v120, v94, v95, v120
    v_max_u32 v120, v120, v122
    v_cmp_eq_u32 vcc, -1, v120
    s_cmp_eq_u64 vcc, 0
    s_cbranch_scc1 L_ok11
    s_bitset1_b32 s84, 2
    buffer_load_dwordx4 v[80:83], v119, s[36:39], s66 offen offset:0 sc1
    buffer_load_dwordx4 v[84:87], v119, s[36:39], s66 offen offset:1024 sc1
    buffer_load_dwordx4 v[88:91], v119, s[36:39], s66 offen offset:2048 sc1
    buffer_load_dwordx4 v[92:95], v119, s[36:39], s66 offen offset:3072 sc1
    ds_read_b64_tr_b16 v[4:5], v2 offset:24576
    ds_read_b64_tr_b16 v[6:7], v2 offset:25088
    ds_read_b64_tr_b16 v[8:9], v3 offset:24576
    ds_read_b64_tr_b16 v[10:11], v3 offset:25088
    ds_read_b64_tr_b16 v[44:45], v2 offset:26624
    ds_read_b64_tr_b16 v[46:47], v2 offset:27136
    ds_read_b64_tr_b16 v[112:113], v3 offset:26624
    ds_read_b64_tr_b16 v[114:115], v3 offset:27136
    s_branch L_nx12
L_ok11:
    s_waitcnt lgkmcnt(6)
    v_mfma_f32_32x32x16_bf16 v[12:27], v[4:7], v[80:83], v[12:27]
    ds_read_b64_tr_b16 v[4:5], v2 offset:20480
    ds_read_b64_tr_b16 v[6:7], v2 offset:20992
    s_waitcnt lgkmcnt(6)
    v_mfma_f32_32x32x16_bf16 v[28:43], v[8:11], v[80:83], v[28:43]
    ds_read_b64_tr_b16 v[8:9], v3 offset:20480
    ds_read_b64_tr_b16 v[10:11], v3 offset:20992
    s_waitcnt lgkmcnt(6)
    v_mfma_f32_32x32x16_bf16 v[12:27], v[44:47], v[84:87], v[12:27]
    ds_read_b64_tr_b16 v[44:45], v2 offset:22528
    ds_read_b64_tr_b16 v[46:47], v2 offset:23040
    s_waitcnt lgkmcnt(6)
    v_mfma_f32_32x32x16_bf16 v[28:43], v[112:115], v[84:87], v[28:43]
    ds_read_b64_tr_b16 v[112:113], v3 offset:22528
    ds_read_b64_tr_b16 v[114:115], v3 offset:23040
    s_waitcnt lgkmcnt(6)
    v_mfma_f32_32x32x16_bf16 v[12:27], v[4:7], v[88:91], v[12:27]
    ds_read_b64_tr_b16 v[4:5], v2 offset:24576
    ds_read_b64_tr_b16 v[6:7], v2 offset:25088
    s_waitcnt lgkmcnt(6)
    v_mfma_f32_32x32x16_bf16 v[28:43], v[8:11], v[88:91], v[28:43]
    ds_read_b64_tr_b16 v[8:9], v3 offset:24576
    ds_read_b64_tr_b16 v[10:11], v3 offset:25088
    s_waitcnt lgkmcnt(6)
    v_mfma_f32_32x32x16_bf16 v[12:27], v[44:47], v[92:95], v[12:27]
    ds_read_b64_tr_b16 v[44:45], v2 offset:26624
    ds_read_b64_tr_b16 v[46:47], v2 offset:27136
    s_waitcnt lgkmcnt(6)
    v_mfma_f32_32x32x16_bf16 v[28:43], v[112:115], v[92:95], v[28:43]
    ds_read_b64_tr_b16 v[112:113], v3 offset:26624
    ds_read_b64_tr_b16 v[114:115], v3 offset:27136
L_nx12:
    s_cmp_eq_u32 s60, 0
    s_cbranch_scc1 L_ok13
    s_waitcnt vmcnt(0)
    v_max3_u32 v120, v96, v97, v98
    v_max3_u32 v122, v99, v100, v101
    v_max3_u32 v120, v102, v103, v120
    v_max3_u32 v122, v104, v105, v122
    v_max3_u32 v120, v106, v107, v120
    v_max3_u32 v122, v108, v109, v122
    v_max3_u32 v120, v110, v111, v120
    v_max_u32 v120, v120, v122
    v_cmp_eq_u32 vcc, -1, v120
    s_cmp_eq_u64 vcc, 0
    s_cbranch_scc1 L_ok13
    s_bitset1_b32 s84, 3
    buffer_load_dwordx4 v[96:99], v119, s[36:39], s67 offen offset:0 sc1
    buffer_load_dwordx4 v[100:103], v119, s[36:39], s67 offen offset:1024 sc1
    buffer_load_dwordx4 v[104:107], v119, s[36:39], s67 offen offset:2048 sc1
    buffer_load_dwordx4 v[108:111], v119, s[36:39], s67 offen offset:3072 sc1
    s_branch L_nx14
L_ok13:
    s_waitcnt lgkmcnt(6)
    v_mfma_f32_32x32x16_bf16 v[12:27], v[4:7], v[96:99], v[12:27]
    ds_read_b64_tr_b16 v[4:5], v2 offset:28672
    ds_read_b64_tr_b16 v[6:7], v2 offset:29184
    s_waitcnt lgkmcnt(6)
    v_mfma_f32_32x32x16_bf16 v[28:43], v[8:11], v[96:99], v[28:43]
    ds_read_b64_tr_b16 v[8:9], v3 offset:28672
    ds_read_b64_tr_b16 v[10:11], v3 offset:29184
    s_waitcnt lgkmcnt(6)
    v_mfma_f32_32x32x16_bf16 v[12:27], v[44:47], v[100:103], v[12:27]
    ds_read_b64_tr_b16 v[44:45], v2 offset:30720
    ds_read_b64_tr_b16 v[46:47], v2 offset:31232
    s_waitcnt lgkmcnt(6)
    v_mfma_f32_32x32x16_bf16 v[28:43], v[112:115], v[100:103], v[28:43]
    ds_read_b64_tr_b16 v[112:113], v3 offset:30720
    ds_read_b64_tr_b16 v[114:115], v3 offset:31232
    s_waitcnt lgkmcnt(6)
    v_mfma_f32_32x32x16_bf16 v[12:27], v[4:7], v[104:107], v[12:27]
    s_waitcnt lgkmcnt(4)
    v_mfma_f32_32x32x16_bf16 v[28:43], v[8:11], v[104:107], v[28:43]
    s_waitcnt lgkmcnt(2)
    v_mfma_f32_32x32x16_bf16 v[12:27], v[44:47], v[108:111], v[12:27]
    s_waitcnt lgkmcnt(0)
    v_mfma_f32_32x32x16_bf16 v[28:43], v[112:115], v[108:111], v[28:43]
L_nx14:
L_opass:
    s_cmp_eq_u32 s84, 0
    s_cbranch_scc1 L_odone
    s_add_u32 s96, s96, 1
    s_waitcnt vmcnt(0)
    s_bitcmp1_b32 s84, 0
    s_cbranch_scc0 L_os15
    ds_read_b64_tr_b16 v[4:5], v2 offset:0
    ds_read_b64_tr_b16 v[6:7], v2 offset:512
    ds_read_b64_tr_b16 v[8:9], v3 offset:0
    ds_read_b64_tr_b16 v[10:11], v3 offset:512
    ds_read_b64_tr_b16 v[44:45], v2 offset:2048
    ds_read_b64_tr_b16 v[46:47], v2 offset:2560
    ds_read_b64_tr_b16 v[112:113], v3 offset:2048
    ds_read_b64_tr_b16 v[114:115], v3 offset:2560
    v_max3_u32 v120, v48, v49, v50
    v_max3_u32 v122, v51, v52, v53
    v_max3_u32 v120, v54, v55, v120
    v_max3_u32 v122, v56, v57, v122
    v_max3_u32 v120, v58, v59, v120
    v_max3_u32 v122, v60, v61, v122
    v_max3_u32 v120, v62, v63, v120
    v_max_u32 v120, v120, v122
    v_cmp_eq_u32 vcc, -1, v120
    s_cmp_gt_u32 s96, 400000
    s_cbranch_scc1 L_ok16
    s_cmp_eq_u64 vcc, 0
    s_cbranch_scc1 L_ok16
    buffer_load_dwordx4 v[48:51], v119, s[36:39], s64 offen offset:0 sc1
    buffer_load_dwordx4 v[52:55], v119, s[36:39], s64 offen offset:1024 sc1
    buffer_load_dwordx4 v[56:59], v119, s[36:39], s64 offen offset:2048 sc1
    buffer_load_dwordx4 v[60:63], v119, s[36:39], s64 offen offset:3072 sc1
    s_branch L_os15
L_ok16:
    s_bitset0_b32 s84, 0
    s_waitcnt lgkmcnt(6)
    v_mfma_f32_32x32x16_bf16 v[12:27], v[4:7], v[48:51], v[12:27]
    ds_read_b64_tr_b16 v[4:5], v2 offset:4096
    ds_read_b64_tr_b16 v[6:7], v2 offset:4608
    s_waitcnt lgkmcnt(6)
    v_mfma_f32_32x32x16_bf16 v[28:43], v[8:11], v[48:51], v[28:43]
    ds_read_b64_tr_b16 v[8:9], v3 offset:4096
    ds_read_b64_tr_b16 v[10:11], v3 offset:4608
    s_waitcnt lgkmcnt(6)
    v_mfma_f32_32x32x16_bf16 v[12:27], v[44:47], v[52:55], v[12:27]
    ds_read_b64_tr_b16 v[44:45], v2 offset:6144
    ds_read_b64_tr_b16 v[46:47], v2 offset:6656
    s_waitcnt lgkmcnt(6)
    v_mfma_f32_32x32x16_bf16 v[28:43], v[112:115], v[52:55], v[28:43]
    ds_read_b64_tr_b16 v[112:113], v3 offset:6144
    ds_read_b64_tr_b16 v[114:115], v3 offset:6656
    s_waitcnt lgkmcnt(6)
    v_mfma_f32_32x32x16_bf16 v[12:27], v[4:7], v[56:59], v[12:27]
    s_waitcnt lgkmcnt(4)
    v_mfma_f32_32x32x16_bf16 v[28:43], v[8:11], v[56:59], v[28:43]
    s_waitcnt lgkmcnt(2)
    v_mfma_f32_32x32x16_bf16 v[12:27], v[44:47], v[60:63], v[12:27]
    s_waitcnt lgkmcnt(0)
    v_mfma_f32_32x32x16_bf16 v[28:43], v[112:115], v[60:63], v[28:43]
L_os15:
    s_bitcmp1_b32 s84, 1
    s_cbranch_scc0 L_os17
    ds_read_b64_tr_b16 v[4:5], v2 offset:8192
    ds_read_b64_tr_b16 v[6:7], v2 offset:8704
    ds_read_b64_tr_b16 v[8:9], v3 offset:8192
    ds_read_b64_tr_b16 v[10:11], v3 offset:8704
    ds_read_b64_tr_b16 v[44:45], v2 offset:10240
    ds_read_b64_tr_b16 v[46:47], v2 offset:10752
    ds_read_b64_tr_b16 v[112:113], v3 offset:10240
    ds_read_b64_tr_b16 v[114:115], v3 offset:10752
    v_max3_u32 v120, v64, v65, v66
    v_max3_u32 v122, v67, v68, v69
    v_max3_u32 v120, v70, v71, v120
    v_max3_u32 v122, v72, v73, v122
    v_max3_u32 v120, v74, v75, v120
    v_max3_u32 v122, v76, v77, v122
    v_max3_u32 v120, v78, v79, v120
    v_max_u32 v120, v120, v122
    v_cmp_eq_u32 vcc, -1, v120
    s_cmp_gt_u32 s96, 400000
    s_cbranch_scc1 L_ok18
    s_cmp_eq_u64 vcc, 0
    s_cbranch_scc1 L_ok18
    buffer_load_dwordx4 v[64:67], v119, s[36:39], s65 offen offset:0 sc1
    buffer_load_dwordx4 v[68:71], v119, s[36:39], s65 offen offset:1024 sc1
    buffer_load_dwordx4 v[72:75], v119, s[36:39], s65 offen offset:2048 sc1
    buffer_load_dwordx4 v[76:79], v119, s[36:39], s65 offen offset:3072 sc1
    s_branch L_os17
L_ok18:
    s_bitset0_b32 s84, 1
    s_waitcnt lgkmcnt(6)
    v_mfma_f32_32x32x16_bf16 v[12:27], v[4:7], v[64:67], v[12:27]
    ds_read_b64_tr_b16 v[4:5], v2 offset:12288
    ds_read_b64_tr_b16 v[6:7], v2 offset:12800
    s_waitcnt lgkmcnt(6)
    v_mfma_f32_32x32x16_bf16 v[28:43], v[8:11], v[64:67], v[28:43]
    ds_read_b64_tr_b16 v[8:9], v3 offset:12288
    ds_read_b64_tr_b16 v[10:11], v3 offset:12800
    s_waitcnt lgkmcnt(6)
    v_mfma_f32_32x32x16_bf16 v[12:27], v[44:47], v[68:71], v[12:27]
    ds_read_b64_tr_b16 v[44:45], v2 offset:14336
    ds_read_b64_tr_b16 v[46:47], v2 offset:14848
    s_waitcnt lgkmcnt(6)
    v_mfma_f32_32x32x16_bf16 v[28:43], v[112:115], v[68:71], v[28:43]
    ds_read_b64_tr_b16 v[112:113], v3 offset:14336
    ds_read_b64_tr_b16 v[114:115], v3 offset:14848
    s_waitcnt lgkmcnt(6)
    v_mfma_f32_32x32x16_bf16 v[12:27], v[4:7], v[72:75], v[12:27]
    s_waitcnt lgkmcnt(4)
    v_mfma_f32_32x32x16_bf16 v[28:43], v[8:11], v[72:75], v[28:43]
    s_waitcnt lgkmcnt(2)
    v_mfma_f32_32x32x16_bf16 v[12:27], v[44:47], v[76:79], v[12:27]
    s_waitcnt lgkmcnt(0)
    v_mfma_f32_32x32x16_bf16 v[28:43], v[112:115], v[76:79], v[28:43]
L_os17:
    s_bitcmp1_b32 s84, 2
    s_cbranch_scc0 L_os19
    ds_read_b64_tr_b16 v[4:5], v2 offset:16384
    ds_read_b64_tr_b16 v[6:7], v2 offset:16896
    ds_read_b64_tr_b16 v[8:9], v3 offset:16384
    ds_read_b64_tr_b16 v[10:11], v3 offset:16896
    ds_read_b64_tr_b16 v[44:45], v2 offset:18432
    ds_read_b64_tr_b16 v[46:47], v2 offset:18944
    ds_read_b64_tr_b16 v[112:113], v3 offset:18432
    ds_read_b64_tr_b16 v[114:115], v3 offset:18944
    v_max3_u32 v120, v80, v81, v82
    v_max3_u32 v122, v83, v84, v85
    v_max3_u32 v120, v86, v87, v120
    v_max3_u32 v122, v88, v89, v122
    v_max3_u32 v120, v90, v91, v120
    v_max3_u32 v122, v92, v93, v122
    v_max3_u32 v120, v94, v95, v120
    v_max_u32 v120, v120, v122
    v_cmp_eq_u32 vcc, -1, v120
    s_cmp_gt_u32 s96, 400000
    s_cbranch_scc1 L_ok20
    s_cmp_eq_u64 vcc, 0
    s_cbranch_scc1 L_ok20
    buffer_load_dwordx4 v[80:83], v119, s[36:39], s66 offen offset:0 sc1
    buffer_load_dwordx4 v[84:87], v119, s[36:39], s66 offen offset:1024 sc1
    buffer_load_dwordx4 v[88:91], v119, s[36:39], s66 offen offset:2048 sc1
    buffer_load_dwordx4 v[92:95], v119, s[36:39], s66 offen offset:3072 sc1
    s_branch L_os19
L_ok20:
    s_bitset0_b32 s84, 2
    s_waitcnt lgkmcnt(6)
    v_mfma_f32_32x32x16_bf16 v[12:27], v[4:7], v[80:83], v[12:27]
    ds_read_b64_tr_b16 v[4:5], v2 offset:20480
    ds_read_b64_tr_b16 v[6:7], v2 offset:20992
    s_waitcnt lgkmcnt(6)
    v_mfma_f32_32x32x16_bf16 v[28:43], v[8:11], v[80:83], v[28:43]
    ds_read_b64_tr_b16 v[8:9], v3 offset:20480
    ds_read_b64_tr_b16 v[10:11], v3 offset:20992
    s_waitcnt lgkmcnt(6)
    v_mfma_f32_32x32x16_bf16 v[12:27], v[44:47], v[84:87], v[12:27]
    ds_read_b64_tr_b16 v[44:45], v2 offset:22528
    ds_read_b64_tr_b16 v[46:47], v2 offset:23040
    s_waitcnt lgkmcnt(6)
    v_mfma_f32_32x32x16_bf16 v[28:43], v[112:115], v[84:87], v[28:43]
    ds_read_b64_tr_b16 v[112:113], v3 offset:22528
    ds_read_b64_tr_b16 v[114:115], v3 offset:23040
    s_waitcnt lgkmcnt(6)
    v_mfma_f32_32x32x16_bf16 v[12:27], v[4:7], v[88:91], v[12:27]
    s_waitcnt lgkmcnt(4)
    v_mfma_f32_32x32x16_bf16 v[28:43], v[8:11], v[88:91], v[28:43]
    s_waitcnt lgkmcnt(2)
    v_mfma_f32_32x32x16_bf16 v[12:27], v[44:47], v[92:95], v[12:27]
    s_waitcnt lgkmcnt(0)
    v_mfma_f32_32x32x16_bf16 v[28:43], v[112:115], v[92:95], v[28:43]
L_os19:
    s_bitcmp1_b32 s84, 3
    s_cbranch_scc0 L_os21
    ds_read_b64_tr_b16 v[4:5], v2 offset:24576
    ds_read_b64_tr_b16 v[6:7], v2 offset:25088
    ds_read_b64_tr_b16 v[8:9], v3 offset:24576
    ds_read_b64_tr_b16 v[10:11], v3 offset:25088
    ds_read_b64_tr_b16 v[44:45], v2 offset:26624
    ds_read_b64_tr_b16 v[46:47], v2 offset:27136
    ds_read_b64_tr_b16 v[112:113], v3 offset:26624
    ds_read_b64_tr_b16 v[114:115], v3 offset:27136
    v_max3_u32 v120, v96, v97, v98
    v_max3_u32 v122, v99, v100, v101
    v_max3_u32 v120, v102, v103, v120
    v_max3_u32 v122, v104, v105, v122
    v_max3_u32 v120, v106, v107, v120
    v_max3_u32 v122, v108, v109, v122
    v_max3_u32 v120, v110, v111, v120
    v_max_u32 v120, v120, v122
    v_cmp_eq_u32 vcc, -1, v120
    s_cmp_gt_u32 s96, 400000
    s_cbranch_scc1 L_ok22
    s_cmp_eq_u64 vcc, 0
    s_cbranch_scc1 L_ok22
    buffer_load_dwordx4 v[96:99], v119, s[36:39], s67 offen offset:0 sc1
    buffer_load_dwordx4 v[100:103], v119, s[36:39], s67 offen offset:1024 sc1
    buffer_load_dwordx4 v[104:107], v119, s[36:39], s67 offen offset:2048 sc1
    buffer_load_dwordx4 v[108:111], v119, s[36:39], s67 offen offset:3072 sc1
    s_branch L_os21
L_ok22:
    s_bitset0_b32 s84, 3
    s_waitcnt lgkmcnt(6)
    v_mfma_f32_32x32x16_bf16 v[12:27], v[4:7], v[96:99], v[12:27]
    ds_read_b64_tr_b16 v[4:5], v2 offset:28672
    ds_read_b64_tr_b16 v[6:7], v2 offset:29184
    s_waitcnt lgkmcnt(6)
    v_mfma_f32_32x32x16_bf16 v[28:43], v[8:11], v[96:99], v[28:43]
    ds_read_b64_tr_b16 v[8:9], v3 offset:28672
    ds_read_b64_tr_b16 v[10:11], v3 offset:29184
    s_waitcnt lgkmcnt(6)
    v_mfma_f32_32x32x16_bf16 v[12:27], v[44:47], v[100:103], v[12:27]
    ds_read_b64_tr_b16 v[44:45], v2 offset:30720
    ds_read_b64_tr_b16 v[46:47], v2 offset:31232
    s_waitcnt lgkmcnt(6)
    v_mfma_f32_32x32x16_bf16 v[28:43], v[112:115], v[100:103], v[28:43]
    ds_read_b64_tr_b16 v[112:113], v3 offset:30720
    ds_read_b64_tr_b16 v[114:115], v3 offset:31232
    s_waitcnt lgkmcnt(6)
    v_mfma_f32_32x32x16_bf16 v[12:27], v[4:7], v[104:107], v[12:27]
    s_waitcnt lgkmcnt(4)
    v_mfma_f32_32x32x16_bf16 v[28:43], v[8:11], v[104:107], v[28:43]
    s_waitcnt lgkmcnt(2)
    v_mfma_f32_32x32x16_bf16 v[12:27], v[44:47], v[108:111], v[12:27]
    s_waitcnt lgkmcnt(0)
    v_mfma_f32_32x32x16_bf16 v[28:43], v[112:115], v[108:111], v[28:43]
L_os21:
    s_branch L_opass
L_odone:
    s_setpc_b64 s[52:53]
L_oload:
    buffer_load_dwordx4 v[48:51], v119, s[36:39], s64 offen offset:0 sc1
    buffer_load_dwordx4 v[52:55], v119, s[36:39], s64 offen offset:1024 sc1
    buffer_load_dwordx4 v[56:59], v119, s[36:39], s64 offen offset:2048 sc1
    buffer_load_dwordx4 v[60:63], v119, s[36:39], s64 offen offset:3072 sc1
    buffer_load_dwordx4 v[64:67], v119, s[36:39], s65 offen offset:0 sc1
    buffer_load_dwordx4 v[68:71], v119, s[36:39], s65 offen offset:1024 sc1
    buffer_load_dwordx4 v[72:75], v119, s[36:39], s65 offen offset:2048 sc1
    buffer_load_dwordx4 v[76:79], v119, s[36:39], s65 offen offset:3072 sc1
    buffer_load_dwordx4 v[80:83], v119, s[36:39], s66 offen offset:0 sc1
    buffer_load_dwordx4 v[84:87], v119, s[36:39], s66 offen offset:1024 sc1
    buffer_load_dwordx4 v[88:91], v119, s[36:39], s66 offen offset:2048 sc1
    buffer_load_dwordx4 v[92:95], v119, s[36:39], s66 offen offset:3072 sc1
    buffer_load_dwordx4 v[96:99], v119, s[36:39], s67 offen offset:0 sc1
    buffer_load_dwordx4 v[100:103], v119, s[36:39], s67 offen offset:1024 sc1
    buffer_load_dwordx4 v[104:107], v119, s[36:39], s67 offen offset:2048 sc1
    buffer_load_dwordx4 v[108:111], v119, s[36:39], s67 offen offset:3072 sc1
    s_setpc_b64 s[52:53]
L_epi:
    s_mov_b32 s94, s59
    s_mov_b32 s95, 4
    s_cmp_eq_u32 s44, 0
    s_nop 4
    s_cbranch_scc1 L_ep0
    ds_write_b128 v124, v[12:15] offset:0
    ds_write_b128 v124, v[16:19] offset:1024
    ds_write_b128 v124, v[20:23] offset:2048
    ds_write_b128 v124, v[24:27] offset:3072
    s_mov_b64 exec, 1
    ds_add_u32 v126, v121 offset:0
    s_mov_b64 exec, -1
    s_branch L_ep1
L_ep0:
    ds_write_b128 v124, v[28:31] offset:0
    ds_write_b128 v124, v[32:35] offset:1024
    ds_write_b128 v124, v[36:39] offset:2048
    ds_write_b128 v124, v[40:43] offset:3072
    s_mov_b64 exec, 1
    ds_add_u32 v126, v121 offset:0
    s_mov_b64 exec, -1
    s_waitcnt lgkmcnt(0)
    v_pk_mov_b32 v[28:29], v[12:13], v[12:13] op_sel:[0,1]
    v_pk_mov_b32 v[30:31], v[14:15], v[14:15] op_sel:[0,1]
    v_pk_mov_b32 v[32:33], v[16:17], v[16:17] op_sel:[0,1]
    v_pk_mov_b32 v[34:35], v[18:19], v[18:19] op_sel:[0,1]
    v_pk_mov_b32 v[36:37], v[20:21], v[20:21] op_sel:[0,1]
    v_pk_mov_b32 v[38:39], v[22:23], v[22:23] op_sel:[0,1]
    v_pk_mov_b32 v[40:41], v[24:25], v[24:25] op_sel:[0,1]
    v_pk_mov_b32 v[42:43], v[26:27], v[26:27] op_sel:[0,1]
L_ep1:
    s_call_b64 s[56:57], L_waitf
    ds_read_b128 v[48:51], v125 offset:0
    ds_read_b128 v[52:55], v125 offset:1024
    ds_read_b128 v[56:59], v125 offset:2048
    ds_read_b128 v[60:63], v125 offset:3072
    s_waitcnt lgkmcnt(2)
    v_pk_add_f32 v[28:29], v[28:29], v[48:49]
    v_pk_add_f32 v[30:31], v[30:31], v[50:51]
    v_pk_add_f32 v[32:33], v[32:33], v[52:53]
    v_pk_add_f32 v[34:35], v[34:35], v[54:55]
    v_cvt_pk_bf16_f32 v64, v28, v29
    v_cvt_pk_bf16_f32 v65, v30, v31
    v_cvt_pk_bf16_f32 v66, v32, v33
    v_cvt_pk_bf16_f32 v67, v34, v35
    s_nop 1
    v_permlane32_swap_b32 v64, v66
    v_permlane32_swap_b32 v65, v67
    buffer_store_dwordx4 v[64:67], v1, s[32:35], s61 offen offset:0
    s_waitcnt lgkmcnt(0)
    v_pk_add_f32 v[36:37], v[36:37], v[56:57]
    v_pk_add_f32 v[38:39], v[38:39], v[58:59]
    v_pk_add_f32 v[40:41], v[40:41], v[60:61]
    v_pk_add_f32 v[42:43], v[42:43], v[62:63]
    v_cvt_pk_bf16_f32 v68, v36, v37
    v_cvt_pk_bf16_f32 v69, v38, v39
    v_cvt_pk_bf16_f32 v70, v40, v41
    v_cvt_pk_bf16_f32 v71, v42, v43
    s_nop 1
    v_permlane32_swap_b32 v68, v70
    v_permlane32_swap_b32 v69, v71
    buffer_store_dwordx4 v[68:71], v1, s[32:35], s61 offen offset:32
    s_setpc_b64 s[52:53]
L_normstore:
    v_rcp_f32 v60, v60
    v_rcp_f32 v61, v61
    s_nop 0
    v_pk_mul_f32 v[28:29], v[28:29], v[60:61] op_sel_hi:[1,0]
    v_pk_mul_f32 v[30:31], v[30:31], v[60:61] op_sel_hi:[1,0]
    v_pk_mul_f32 v[32:33], v[32:33], v[60:61] op_sel_hi:[1,0]
    v_pk_mul_f32 v[34:35], v[34:35], v[60:61] op_sel_hi:[1,0]
    v_pk_mul_f32 v[44:45], v[44:45], v[60:61] op_sel:[0,1]
    v_pk_mul_f32 v[46:47], v[46:47], v[60:61] op_sel:[0,1]
    v_pk_mul_f32 v[48:49], v[48:49], v[60:61] op_sel:[0,1]
    v_pk_mul_f32 v[50:51], v[50:51], v[60:61] op_sel:[0,1]
    v_cvt_pk_bf16_f32 v64, v28, v29
    v_cvt_pk_bf16_f32 v65, v30, v31
    v_cvt_pk_bf16_f32 v66, v32, v33
    v_cvt_pk_bf16_f32 v67, v34, v35
    v_cvt_pk_bf16_f32 v68, v44, v45
    v_cvt_pk_bf16_f32 v69, v46, v47
    v_cvt_pk_bf16_f32 v70, v48, v49
    v_cvt_pk_bf16_f32 v71, v50, v51
    v_permlane32_swap_b32 v64, v66
    v_permlane32_swap_b32 v65, v67
    v_permlane32_swap_b32 v68, v70
    v_permlane32_swap_b32 v69, v71
    buffer_store_dwordx4 v[64:67], v119, s[36:39], s88 offen sc1
    buffer_store_dwordx4 v[68:71], v119, s[36:39], s88 offen offset:1024 sc1
    s_setpc_b64 s[52:53]
L_fallback:
    v_mov_b32 v22, 0xff800000
    v_mov_b32 v23, 0xff800000
    s_mov_b32 s86, 0
L_mx:
    s_lshr_b32 s87, s86, 1
    s_lshl_b32 s87, s87, 12
    s_and_b32 s89, s86, 1
    s_lshl_b32 s89, s89, 10
    s_add_u32 s87, s87, s89
    s_add_u32 s87, s87, 65536
    s_add_u32 s86, s86, 1
    buffer_load_dwordx4 v[92:95], v119, s[36:39], s87 offen sc1
    s_waitcnt vmcnt(0)
    v_mfma_f32_32x32x16_bf16 v[60:75], v[92:95], v[4:7], 0
    v_mfma_f32_32x32x16_bf16 v[76:91], v[92:95], v[8:11], 0
    s_nop 11
    v_max3_f32 v22, v60, v61, v22
    v_max3_f32 v22, v62, v63, v22
    v_max3_f32 v22, v64, v65, v22
    v_max3_f32 v22, v66, v67, v22
    v_max3_f32 v22, v68, v69, v22
    v_max3_f32 v22, v70, v71, v22
    v_max3_f32 v22, v72, v73, v22
    v_max3_f32 v22, v74, v75, v22
    v_max3_f32 v23, v76, v77, v23
    v_max3_f32 v23, v78, v79, v23
    v_max3_f32 v23, v80, v81, v23
    v_max3_f32 v23, v82, v83, v23
    v_max3_f32 v23, v84, v85, v23
    v_max3_f32 v23, v86, v87, v23
    v_max3_f32 v23, v88, v89, v23
    v_max3_f32 v23, v90, v91, v23
    s_cmp_lt_u32 s86, 64
    s_cbranch_scc1 L_mx
    v_mov_b32 v60, v22
    v_mov_b32 v61, v23
    s_nop 1
    v_permlane32_swap_b32 v22, v60
    v_permlane32_swap_b32 v23, v61
    v_max_f32 v22, v22, v60
    v_max_f32 v23, v23, v61
    v_mov_b32 v28, 0
    v_mov_b32 v44, 0
    v_mov_b32 v29, 0
    v_mov_b32 v45, 0
    v_mov_b32 v30, 0
    v_mov_b32 v46, 0
    v_mov_b32 v31, 0
    v_mov_b32 v47, 0
    v_mov_b32 v32, 0
    v_mov_b32 v48, 0
    v_mov_b32 v33, 0
    v_mov_b32 v49, 0
    v_mov_b32 v34, 0
    v_mov_b32 v50, 0
    v_mov_b32 v35, 0
    v_mov_b32 v51, 0
    v_mov_b32 v36, 0
    v_mov_b32 v52, 0
    v_mov_b32 v100, 0x3f803f80
    v_mov_b32 v101, 0x3f803f80
    v_mov_b32 v102, 0x3f803f80
    v_mov_b32 v103, 0x3f803f80
    v_mov_b32 v104, 0x3f803f80
    v_mov_b32 v105, 0x3f803f80
    v_mov_b32 v106, 0x3f803f80
    v_mov_b32 v107, 0x3f803f80
    v_mov_b32 v21, v13
    s_mov_b32 s86, 0
L_fl:
    s_lshr_b32 s87, s86, 1
    s_lshl_b32 s87, s87, 12
    s_and_b32 s89, s86, 1
    s_lshl_b32 s89, s89, 10
    s_add_u32 s87, s87, s89
    s_add_u32 s87, s87, 65536
    s_add_u32 s86, s86, 1
    buffer_load_dwordx4 v[92:95], v119, s[36:39], s87 offen sc1
    s_mov_b64 exec, s[92:93]
    buffer_load_dwordx4 v[100:103], v21, s[36:39], s87 offen sc1
    buffer_load_dwordx4 v[104:107], v21, s[36:39], s87 offen offset:512 sc1
    s_mov_b64 exec, -1
    s_waitcnt vmcnt(0)
    v_mfma_f32_32x32x16_bf16 v[60:75], v[92:95], v[4:7], 0
    v_mfma_f32_32x32x16_bf16 v[76:91], v[92:95], v[8:11], 0
    s_nop 11
    v_sub_f32 v60, v60, v22
    v_sub_f32 v61, v61, v22
    v_sub_f32 v62, v62, v22
    v_sub_f32 v63, v63, v22
    v_sub_f32 v64, v64, v22
    v_sub_f32 v65, v65, v22
    v_sub_f32 v66, v66, v22
    v_sub_f32 v67, v67, v22
    v_sub_f32 v68, v68, v22
    v_sub_f32 v69, v69, v22
    v_sub_f32 v70, v70, v22
    v_sub_f32 v71, v71, v22
    v_sub_f32 v72, v72, v22
    v_sub_f32 v73, v73, v22
    v_sub_f32 v74, v74, v22
    v_sub_f32 v75, v75, v22
    v_sub_f32 v76, v76, v23
    v_sub_f32 v77, v77, v23
    v_sub_f32 v78, v78, v23
    v_sub_f32 v79, v79, v23
    v_sub_f32 v80, v80, v23
    v_sub_f32 v81, v81, v23
    v_sub_f32 v82, v82, v23
    v_sub_f32 v83, v83, v23
    v_sub_f32 v84, v84, v23
    v_sub_f32 v85, v85, v23
    v_sub_f32 v86, v86, v23
    v_sub_f32 v87, v87, v23
    v_sub_f32 v88, v88, v23
    v_sub_f32 v89, v89, v23
    v_sub_f32 v90, v90, v23
    v_sub_f32 v91, v91, v23
    v_exp_f32 v60, v60
    v_exp_f32 v61, v61
    v_exp_f32 v62, v62
    v_exp_f32 v63, v63
    v_exp_f32 v64, v64
    v_exp_f32 v65, v65
    v_exp_f32 v66, v66
    v_exp_f32 v67, v67
    v_exp_f32 v68, v68
    v_exp_f32 v69, v69
    v_exp_f32 v70, v70
    v_exp_f32 v71, v71
    v_exp_f32 v72, v72
    v_exp_f32 v73, v73
    v_exp_f32 v74, v74
    v_exp_f32 v75, v75
    v_exp_f32 v76, v76
    v_exp_f32 v77, v77
    v_exp_f32 v78, v78
    v_exp_f32 v79, v79
    v_exp_f32 v80, v80
    v_exp_f32 v81, v81
    v_exp_f32 v82, v82
    v_exp_f32 v83, v83
    v_exp_f32 v84, v84
    v_exp_f32 v85, v85
    v_exp_f32 v86, v86
    v_exp_f32 v87, v87
    v_exp_f32 v88, v88
    v_exp_f32 v89, v89
    v_exp_f32 v90, v90
    v_exp_f32 v91, v91
    s_nop 1
    v_smfmac_f32_32x32x32_bf16 v[28:43], v[100:103], v[60:67], v3
    v_smfmac_f32_32x32x32_bf16 v[28:43], v[104:107], v[68:75], v3
    v_smfmac_f32_32x32x32_bf16 v[44:59], v[100:103], v[76:83], v3
    v_smfmac_f32_32x32x32_bf16 v[44:59], v[104:107], v[84:91], v3
    s_nop 11
    s_cmp_lt_u32 s86, 64
    s_cbranch_scc1 L_fl
    v_mov_b32 v60, v36
    v_mov_b32 v61, v52
    s_branch L_norm
L_end:
    s_endpgm
.section .rodata,"a"
.p2align 6
.amdhsa_kernel concat_heads__linear_attn_block__grouped_kv_mqa__prompt_kernel
  .amdhsa_next_free_vgpr 128
  .amdhsa_next_free_sgpr 102
  .amdhsa_accum_offset 128
  .amdhsa_group_segment_fixed_size 0
  .amdhsa_kernarg_size 88
  .amdhsa_user_sgpr_count 2
  .amdhsa_user_sgpr_kernarg_segment_ptr 1
  .amdhsa_system_sgpr_workgroup_id_x 1
.end_amdhsa_kernel
```
